```python
import torch

def _softmax(x, axis=-1):
    return torch.softmax(x, dim=axis)

def _gelu(x):
    return torch.nn.functional.gelu(x, approximate='tanh')

def _silu(x):
    return torch.nn.functional.silu(x)

def _sigmoid(x):
    return torch.sigmoid(x)

def _layernorm(x, axis=-1, eps=1e-05):
    m = x.mean(dim=axis, keepdim=True)
    v = x.var(dim=axis, keepdim=True, unbiased=False)
    return (x - m) / torch.sqrt(v + eps)

def _scatter_add(tgt, idx, src, axis=0):
    return tgt.clone().index_add_(axis, idx, src)

def _segment_sum(src, seg, n):
    out = torch.zeros((n,) + src.shape[1:], dtype=src.dtype)
    return out.index_add_(0, seg, src)

def _pad(x, pw):
    flat = tuple((v for pair in reversed(pw) for v in pair))
    return torch.nn.functional.pad(x, flat)
kernel_name = 'adaLN_cond__gqa_block_cached__dense_activation_relu__decode'

def setup_inputs():

    _w = lambda a: (lambda t: t.to(torch.bfloat16) if t.is_floating_point() else t)(torch.as_tensor(a))

    def _A_setup():
        B, Sq, D = (8, 1, 576)
        Hq, Hkv, Sk, Dh = (32, 16, 4096, 128)
        assert Hq % Hkv == 0, (Hq, Hkv)
        return {'x': _w((lambda *s: torch.randn(*s, dtype=torch.bfloat16) * 0.05)(B, Sq, D)), 'k_cache': _w((lambda *s: torch.randn(*s, dtype=torch.bfloat16) * 3.2)(B, Hkv, Sk, Dh)), 'v_cache': _w((lambda *s: torch.randn(*s, dtype=torch.bfloat16) * 0.4)(B, Hkv, Sk, Dh)), 'wq': _w((lambda *s: torch.randn(*s, dtype=torch.bfloat16) * 3.2)(D, Hq * Dh) * D ** (-0.5)), 'wo': _w((lambda *s: torch.randn(*s, dtype=torch.bfloat16) * 0.4)(Hq * Dh, D) * (Hq * Dh) ** (-0.5))}
    _A_in = _A_setup()

    def _B_setup():
        B, S, D, Dff = (8, 1, 576, 4608)
        return {'x': _w((lambda *s: torch.randn(*s, dtype=torch.bfloat16) * 0.05)(B, S, D)), 'w1': _w((lambda *s: torch.randn(*s, dtype=torch.bfloat16) * 0.05)(D, Dff)), 'w2': _w((lambda *s: torch.randn(*s, dtype=torch.bfloat16) * 0.05)(Dff, D))}
    _B_in = _B_setup()
    return {'A_x': _A_in['x'], 'A_k_cache': _A_in['k_cache'], 'A_v_cache': _A_in['v_cache'], 'A_wq': _A_in['wq'], 'A_wo': _A_in['wo'], 'B_x': _B_in['x'], 'B_w1': _B_in['w1'], 'B_w2': _B_in['w2'], 'c': _w((lambda *s: torch.randn(*s, dtype=torch.bfloat16) * 0.2)(8, 576) * 8.0), 'w_mod': _w((lambda *s: torch.randn(*s, dtype=torch.bfloat16) * 0.2)(576, 6 * 576) * 576 ** (-0.5) * 8.0)}

def reference(A_x, A_k_cache, A_v_cache, A_wq, A_wo, B_x, B_w1, B_w2, c, w_mod):

    def _A_ref(x, k_cache, v_cache, wq, wo):
        B, Sq, D = x.shape
        Hq, Dh = (32, 128)
        Hkv = k_cache.shape[1]
        rep = Hq // Hkv
        q = (lambda x, *d: x.permute(*d))((x @ wq).reshape(B, Sq, Hq, Dh), 0, 2, 1, 3)
        k = (lambda x, n, axis: torch.repeat_interleave(x, n, dim=axis))(k_cache, rep, axis=1)
        v = (lambda x, n, axis: torch.repeat_interleave(x, n, dim=axis))(v_cache, rep, axis=1)
        scores = torch.einsum('bhqd,bhkd->bhqk', q, k) * Dh ** (-0.5)
        p = _softmax(scores, axis=-1)
        o = torch.einsum('bhqk,bhkd->bhqd', p, v)
        return (lambda x, *d: x.permute(*d))(o, 0, 2, 1, 3).reshape(B, Sq, Hq * Dh) @ wo

    def _B_ref(x, w1, w2):
        h = torch.einsum('bsd,df->bsf', x, w1)
        zero = torch.zeros_like(h)
        h = torch.maximum(h, zero)
        return torch.einsum('bsf,fd->bsd', h, w2)
    x = A_x
    mod = (_silu(c) @ w_mod).reshape(c.shape[0], 6, 1, -1)
    sa, ca, ga, sb, cb, gb = (mod[:, 0].clone(), mod[:, 1].clone(), mod[:, 2].clone(), mod[:, 3].clone(), mod[:, 4].clone(), mod[:, 5].clone())
    h = _layernorm(x, axis=-1) * (1 + ca) + sa
    x = x + ga * _A_ref(h, A_k_cache, A_v_cache, A_wq, A_wo)
    h = _layernorm(x, axis=-1) * (1 + cb) + sb
    x = x + gb * _B_ref(h, B_w1, B_w2)
    return x
```

```asm
; @launch grid=(256,1,1) block=(512,1,1) lds=163840
.amdgcn_target "amdgcn-amd-amdhsa--gfx950"
.text
.globl adaLN_cond__gqa_block_cached__dense_activation_relu__decode_kernel
.p2align 10
.fill 64, 4, 0xBF800000
.p2align 8
.type adaLN_cond__gqa_block_cached__dense_activation_relu__decode_kernel,@function
adaLN_cond__gqa_block_cached__dense_activation_relu__decode_kernel:
    s_cmp_ge_u32 s2, 256
    s_cbranch_scc1 L_end
    s_load_dwordx16 s[4:19], s[0:1], 0
    s_load_dwordx8 s[20:27], s[0:1], 64
    s_load_dwordx2 s[28:29], s[0:1], 96
    v_lshrrev_b32 v1, 6, v0
    v_and_b32 v0, 63, v0
    v_readfirstlane_b32 s64, v1
    v_lshlrev_b32 v1, 4, v0
    s_cmp_ge_u32 s2, 138
    s_cbranch_scc1 L_head
    s_lshr_b32 s67, s2, 7
    s_mul_i32 s80, s67, 133
    s_xor_b32 s79, s2, s80
    s_lshr_b32 s65, s79, 4
    s_and_b32 s66, s79, 15
    s_lshl_b32 s79, s79, 20
    s_cmp_eq_u32 s67, 0
    s_cselect_b32 s3, 0, 0xff000
    s_movk_i32 s87, 0x1000
    s_cselect_b32 s87, s87, 0xfffff000
    s_mov_b32 s34, 0x100000
    s_mov_b32 s35, 0x20000
    s_mov_b32 s38, s34
    s_mov_b32 s39, s35
    s_mul_i32 s75, s64, s87
    s_add_u32 s75, s75, s3
    s_waitcnt lgkmcnt(0)
    s_add_u32 s32, s6, s79
    s_addc_u32 s33, s7, 0
    s_add_u32 s36, s8, s79
    s_addc_u32 s37, s9, 0
    s_cmp_eq_u32 s64, 7
    s_cbranch_scc1 L_nok
    buffer_load_dwordx4 v[64:67], v1, s[32:35], s75 offen offset:0 nt
    buffer_load_dwordx4 v[80:83], v1, s[36:39], s75 offen offset:0 nt
    buffer_load_dwordx4 v[68:71], v1, s[32:35], s75 offen offset:1024 nt
    buffer_load_dwordx4 v[72:75], v1, s[32:35], s75 offen offset:2048 nt
    buffer_load_dwordx4 v[76:79], v1, s[32:35], s75 offen offset:3072 nt
    buffer_load_dwordx4 v[84:87], v1, s[36:39], s75 offen offset:1024 nt
    buffer_load_dwordx4 v[88:91], v1, s[36:39], s75 offen offset:2048 nt
    buffer_load_dwordx4 v[92:95], v1, s[36:39], s75 offen offset:3072 nt
L_nok:
    v_mov_b32 v4, 15360
    v_mov_b32 v8, 8
    v_mov_b32 v9, 0
    v_mov_b32 v10, 96
    v_mov_b32 v11, 0
    v_mov_b32 v12, 0
    ds_write_b64 v4, v[8:9]
    ds_write_b96 v4, v[10:12] offset:16
    v_mov_b32 v6, 1
    s_mov_b32 s74, 0
    s_mov_b32 s69, 0xffff0000
    s_mov_b32 s70, 0x3fb8aa3b
    s_mov_b32 s71, 0x3db504f3
    s_mov_b32 s60, s28
    s_mov_b32 s61, s29
    s_mov_b32 s62, 3293184
    s_mov_b32 s63, 0x20000
    s_waitcnt lgkmcnt(0)
    s_load_dword s57, s[28:29], 0
    s_barrier
    s_cmp_eq_u32 s64, 7
    s_cbranch_scc1 L_qsvc
    s_branch L_stream1
L_head:
    s_sub_u32 s68, s2, 138
    s_mul_i32 s79, s64, 1152
    v_lshlrev_b32 v43, 2, v0
    v_add_u32 v44, s79, v43
    v_mov_b32 v52, 0
    s_waitcnt lgkmcnt(0)
    s_cmp_lt_u32 s68, 54
    s_cselect_b32 s30, s20, s4
    s_cselect_b32 s31, s21, s5
    s_cselect_b32 s52, s22, s10
    s_cselect_b32 s53, s23, s11
    s_mov_b32 s80, 4718592
    s_cselect_b32 s54, 3981312, s80
    s_mov_b32 s55, 0x20000
    s_mov_b32 s80, 8192
    s_cselect_b32 s85, 6912, s80
    s_cselect_b32 s80, 0, 54
    s_sub_u32 s84, s68, s80
    s_lshl_b32 s84, s84, 7
    global_load_dword v48, v44, s[30:31] offset:0
    global_load_dword v49, v44, s[30:31] offset:256
    global_load_dword v50, v44, s[30:31] offset:512
    global_load_dword v51, v44, s[30:31] offset:768
    s_mov_b32 exec_lo, 0xffffffff
    s_mov_b32 exec_hi, 0x0
    global_load_dword v52, v44, s[30:31] offset:1024
    s_mov_b64 exec, -1
    v_lshrrev_b32 v45, 3, v0
    v_mul_u32_u24 v45, s85, v45
    v_and_b32 v47, 7, v0
    v_bfe_u32 v46, v0, 4, 1
    v_lshlrev_b32 v46, 1, v46
    v_xor_b32 v47, v47, v46
    v_lshl_add_u32 v45, v47, 4, v45
    v_xor_b32 v46, 64, v45
    s_and_b32 s79, s64, 1
    s_lshl_b32 s79, s79, 6
    v_xor_b32 v45, s79, v45
    v_xor_b32 v46, s79, v46
    s_mul_i32 s79, s64, 72
    s_mul_i32 s79, s79, s85
    s_add_u32 s79, s79, s84
    s_lshl_b32 s80, s85, 3
    s_mul_i32 s81, s64, 9216
    s_add_u32 s81, s81, 16384
    s_barrier
    s_mov_b32 m0, s81
    s_nop 0
    buffer_load_dwordx4 v45, s[52:55], s79 offen nt lds
    s_add_u32 m0, m0, 1024
    s_add_u32 s79, s79, s80
    buffer_load_dwordx4 v46, s[52:55], s79 offen nt lds
    s_add_u32 m0, m0, 1024
    s_add_u32 s79, s79, s80
    buffer_load_dwordx4 v45, s[52:55], s79 offen nt lds
    s_add_u32 m0, m0, 1024
    s_add_u32 s79, s79, s80
    buffer_load_dwordx4 v46, s[52:55], s79 offen nt lds
    s_add_u32 m0, m0, 1024
    s_add_u32 s79, s79, s80
    buffer_load_dwordx4 v45, s[52:55], s79 offen nt lds
    s_add_u32 m0, m0, 1024
    s_add_u32 s79, s79, s80
    buffer_load_dwordx4 v46, s[52:55], s79 offen nt lds
    s_add_u32 m0, m0, 1024
    s_add_u32 s79, s79, s80
    buffer_load_dwordx4 v45, s[52:55], s79 offen nt lds
    s_add_u32 m0, m0, 1024
    s_add_u32 s79, s79, s80
    buffer_load_dwordx4 v46, s[52:55], s79 offen nt lds
    s_add_u32 m0, m0, 1024
    s_add_u32 s79, s79, s80
    buffer_load_dwordx4 v45, s[52:55], s79 offen nt lds
    s_load_dword s57, s[28:29], 0
    s_lshr_b32 s67, s2, 7
    s_mul_i32 s80, s67, 133
    s_xor_b32 s79, s2, s80
    s_lshr_b32 s65, s79, 4
    s_and_b32 s66, s79, 15
    s_lshl_b32 s79, s79, 20
    s_cmp_eq_u32 s67, 0
    s_cselect_b32 s3, 0, 0xff000
    s_movk_i32 s87, 0x1000
    s_cselect_b32 s87, s87, 0xfffff000
    s_mov_b32 s34, 0x100000
    s_mov_b32 s35, 0x20000
    s_mov_b32 s38, s34
    s_mov_b32 s39, s35
    s_mul_i32 s75, s64, s87
    s_add_u32 s75, s75, s3
    s_add_u32 s32, s6, s79
    s_addc_u32 s33, s7, 0
    s_add_u32 s36, s8, s79
    s_addc_u32 s37, s9, 0
    v_mov_b32 v4, 15360
    v_mov_b32 v8, 8
    v_mov_b32 v9, 0
    v_mov_b32 v10, 96
    v_mov_b32 v11, 0
    v_mov_b32 v12, 0
    ds_write_b64 v4, v[8:9]
    ds_write_b96 v4, v[10:12] offset:16
    v_mov_b32 v6, 1
    s_mov_b32 s74, 0
    s_mov_b32 s69, 0xffff0000
    s_mov_b32 s70, 0x3fb8aa3b
    s_mov_b32 s71, 0x3db504f3
    s_mov_b32 s60, s28
    s_mov_b32 s61, s29
    s_mov_b32 s62, 3293184
    s_mov_b32 s63, 0x20000
    s_sub_u32 s79, s68, 18
    s_cmp_ge_u32 s79, 36
    s_cbranch_scc1 L_head2
    buffer_load_dwordx4 v[64:67], v1, s[32:35], s75 offen offset:0 nt
    buffer_load_dwordx4 v[68:71], v1, s[32:35], s75 offen offset:1024 nt
    buffer_load_dwordx4 v[72:75], v1, s[32:35], s75 offen offset:2048 nt
    buffer_load_dwordx4 v[76:79], v1, s[32:35], s75 offen offset:3072 nt
    buffer_load_dwordx4 v[80:83], v1, s[36:39], s75 offen offset:0 nt
    buffer_load_dwordx4 v[84:87], v1, s[36:39], s75 offen offset:1024 nt
    buffer_load_dwordx4 v[88:91], v1, s[36:39], s75 offen offset:2048 nt
    buffer_load_dwordx4 v[92:95], v1, s[36:39], s75 offen offset:3072 nt
    s_branch L_head2
L_stream:
    buffer_load_dwordx4 v[64:67], v1, s[32:35], s75 offen offset:0 nt
    buffer_load_dwordx4 v[68:71], v1, s[32:35], s75 offen offset:1024 nt
    buffer_load_dwordx4 v[72:75], v1, s[32:35], s75 offen offset:2048 nt
    buffer_load_dwordx4 v[76:79], v1, s[32:35], s75 offen offset:3072 nt
    s_waitcnt vmcnt(3)
    buffer_load_dwordx4 v[80:83], v1, s[36:39], s75 offen offset:0 nt
    s_waitcnt vmcnt(3)
    buffer_load_dwordx4 v[84:87], v1, s[36:39], s75 offen offset:1024 nt
    s_waitcnt vmcnt(3)
    buffer_load_dwordx4 v[88:91], v1, s[36:39], s75 offen offset:2048 nt
    s_waitcnt vmcnt(3)
    buffer_load_dwordx4 v[92:95], v1, s[36:39], s75 offen offset:3072 nt
L_stream1:
    s_mov_b32 s73, 1
    s_mov_b32 s86, 0
    s_sub_u32 s78, s2, 64
    s_sub_u32 s53, s2, 64
    s_cmp_lt_u32 s2, 64
    s_cselect_b32 s53, s2, s53
    s_sub_u32 s79, s2, 64
    s_cmp_lt_u32 s79, 64
    s_cselect_b32 s53, 255, s53
    s_cmp_ge_u32 s2, 128
    s_cselect_b32 s78, 255, s78
    s_sub_u32 s79, s2, 72
    s_cmp_ge_u32 s2, 136
    s_cselect_b32 s78, s79, s78
    s_cmp_ge_u32 s2, 192
    s_cselect_b32 s78, 255, s78
    s_sub_u32 s79, s2, 80
    s_cmp_ge_u32 s2, 200
    s_cselect_b32 s78, s79, s78
    s_lshl_b32 s55, s64, 13
    s_add_u32 s55, s55, 16384
    s_add_u32 s79, s55, 73728
    s_cmp_lt_u32 s53, 72
    s_cselect_b32 s55, s55, s79
    s_cbranch_scc1 L_fdma
    s_branch L_nodma
L_fdma:
    s_mov_b32 s48, s18
    s_mov_b32 s49, s19
    s_mov_b32 s50, 5308416
    s_mov_b32 s51, 0x20000
    s_mul_i32 s79, s64, 9216
    s_mul_i32 s80, s53, 73728
    s_add_u32 s79, s79, s80
    s_mul_i32 s81, s64, 9216
    s_add_u32 m0, s81, 90112
    s_waitcnt vmcnt(3)
    buffer_load_dwordx4 v1, s[48:51], s79 offen nt lds
    s_add_u32 m0, m0, 1024
    s_add_u32 s79, s79, 1024
    s_waitcnt vmcnt(3)
    buffer_load_dwordx4 v1, s[48:51], s79 offen nt lds
    s_add_u32 m0, m0, 1024
    s_add_u32 s79, s79, 1024
    s_waitcnt vmcnt(3)
    buffer_load_dwordx4 v1, s[48:51], s79 offen nt lds
    s_add_u32 m0, m0, 1024
    s_add_u32 s79, s79, 1024
    s_waitcnt vmcnt(3)
    buffer_load_dwordx4 v1, s[48:51], s79 offen nt lds
    s_add_u32 m0, m0, 1024
    s_add_u32 s79, s79, 1024
    s_waitcnt vmcnt(3)
    buffer_load_dwordx4 v1, s[48:51], s79 offen nt lds
    s_add_u32 m0, m0, 1024
    s_add_u32 s79, s79, 1024
    s_waitcnt vmcnt(3)
    buffer_load_dwordx4 v1, s[48:51], s79 offen nt lds
    s_add_u32 m0, m0, 1024
    s_add_u32 s79, s79, 1024
    s_waitcnt vmcnt(3)
    buffer_load_dwordx4 v1, s[48:51], s79 offen nt lds
    s_add_u32 m0, m0, 1024
    s_add_u32 s79, s79, 1024
    s_waitcnt vmcnt(3)
    buffer_load_dwordx4 v1, s[48:51], s79 offen nt lds
    s_add_u32 m0, m0, 1024
    s_add_u32 s79, s79, 1024
    s_waitcnt vmcnt(3)
    buffer_load_dwordx4 v1, s[48:51], s79 offen nt lds
L_nodma:
    ds_read_b32 v7, v4 offset:4
    s_waitcnt lgkmcnt(0)
    v_readfirstlane_b32 s80, v7
    s_nop 0
    s_cmp_lg_u32 s80, 0
    s_cbranch_scc1 L_qready
    s_mov_b64 exec, 1
    ds_add_rtn_u32 v5, v4, v6
    s_mov_b64 exec, -1
    s_waitcnt lgkmcnt(0)
    v_readfirstlane_b32 s79, v5
    s_nop 0
    s_mul_i32 s75, s79, s87
    s_add_u32 s75, s75, s3
    s_bitset1_b32 s74, 0
    s_waitcnt vmcnt(3)
    buffer_load_dwordx4 v[96:99], v1, s[32:35], s75 offen offset:0 nt
    s_waitcnt vmcnt(3)
    buffer_load_dwordx4 v[100:103], v1, s[32:35], s75 offen offset:1024 nt
    s_waitcnt vmcnt(3)
    buffer_load_dwordx4 v[104:107], v1, s[32:35], s75 offen offset:2048 nt
    s_waitcnt vmcnt(3)
    buffer_load_dwordx4 v[108:111], v1, s[32:35], s75 offen offset:3072 nt
    s_waitcnt vmcnt(3)
    buffer_load_dwordx4 v[112:115], v1, s[36:39], s75 offen offset:0 nt
    s_waitcnt vmcnt(3)
    buffer_load_dwordx4 v[116:119], v1, s[36:39], s75 offen offset:1024 nt
    s_waitcnt vmcnt(3)
    buffer_load_dwordx4 v[120:123], v1, s[36:39], s75 offen offset:2048 nt
    s_waitcnt vmcnt(3)
    buffer_load_dwordx4 v[124:127], v1, s[36:39], s75 offen offset:3072 nt
L_slot1:
    ds_read_b32 v7, v4 offset:4
    s_waitcnt lgkmcnt(0)
    v_readfirstlane_b32 s80, v7
    s_nop 0
    s_cmp_lg_u32 s80, 0
    s_cbranch_scc1 L_qready
    s_mov_b64 exec, 1
    ds_add_rtn_u32 v5, v4, v6
    s_mov_b64 exec, -1
    s_waitcnt lgkmcnt(0)
    v_readfirstlane_b32 s79, v5
    s_nop 0
    s_mul_i32 s75, s79, s87
    s_add_u32 s75, s75, s3
    s_bitset1_b32 s74, 1
    s_waitcnt vmcnt(3)
    buffer_load_dwordx4 v[128:131], v1, s[32:35], s75 offen offset:0 nt
    s_waitcnt vmcnt(3)
    buffer_load_dwordx4 v[132:135], v1, s[32:35], s75 offen offset:1024 nt
    s_waitcnt vmcnt(3)
    buffer_load_dwordx4 v[136:139], v1, s[32:35], s75 offen offset:2048 nt
    s_waitcnt vmcnt(3)
    buffer_load_dwordx4 v[140:143], v1, s[32:35], s75 offen offset:3072 nt
    s_waitcnt vmcnt(3)
    buffer_load_dwordx4 v[144:147], v1, s[36:39], s75 offen offset:0 nt
    s_waitcnt vmcnt(3)
    buffer_load_dwordx4 v[148:151], v1, s[36:39], s75 offen offset:1024 nt
    s_waitcnt vmcnt(3)
    buffer_load_dwordx4 v[152:155], v1, s[36:39], s75 offen offset:2048 nt
    s_waitcnt vmcnt(3)
    buffer_load_dwordx4 v[156:159], v1, s[36:39], s75 offen offset:3072 nt
L_slot2:
    ds_read_b32 v7, v4 offset:4
    s_waitcnt lgkmcnt(0)
    v_readfirstlane_b32 s80, v7
    s_nop 0
    s_cmp_lg_u32 s80, 0
    s_cbranch_scc1 L_qready
    s_mov_b64 exec, 1
    ds_add_rtn_u32 v5, v4, v6
    s_mov_b64 exec, -1
    s_waitcnt lgkmcnt(0)
    v_readfirstlane_b32 s79, v5
    s_nop 0
    s_mul_i32 s75, s79, s87
    s_add_u32 s75, s75, s3
    s_bitset1_b32 s74, 2
    s_waitcnt vmcnt(3)
    buffer_load_dwordx4 v[160:163], v1, s[32:35], s75 offen offset:0 nt
    s_waitcnt vmcnt(3)
    buffer_load_dwordx4 v[164:167], v1, s[32:35], s75 offen offset:1024 nt
    s_waitcnt vmcnt(3)
    buffer_load_dwordx4 v[168:171], v1, s[32:35], s75 offen offset:2048 nt
    s_waitcnt vmcnt(3)
    buffer_load_dwordx4 v[172:175], v1, s[32:35], s75 offen offset:3072 nt
    s_waitcnt vmcnt(3)
    buffer_load_dwordx4 v[176:179], v1, s[36:39], s75 offen offset:0 nt
    s_waitcnt vmcnt(3)
    buffer_load_dwordx4 v[180:183], v1, s[36:39], s75 offen offset:1024 nt
    s_waitcnt vmcnt(3)
    buffer_load_dwordx4 v[184:187], v1, s[36:39], s75 offen offset:2048 nt
    s_waitcnt vmcnt(3)
    buffer_load_dwordx4 v[188:191], v1, s[36:39], s75 offen offset:3072 nt
L_slot3:
    ds_read_b32 v7, v4 offset:4
    s_waitcnt lgkmcnt(0)
    v_readfirstlane_b32 s80, v7
    s_nop 0
    s_cmp_lg_u32 s80, 0
    s_cbranch_scc1 L_qready
    s_mov_b64 exec, 1
    ds_add_rtn_u32 v5, v4, v6
    s_mov_b64 exec, -1
    s_waitcnt lgkmcnt(0)
    v_readfirstlane_b32 s79, v5
    s_nop 0
    s_mul_i32 s75, s79, s87
    s_add_u32 s75, s75, s3
    s_bitset1_b32 s74, 3
    s_waitcnt vmcnt(3)
    buffer_load_dwordx4 v[192:195], v1, s[32:35], s75 offen offset:0 nt
    s_waitcnt vmcnt(3)
    buffer_load_dwordx4 v[196:199], v1, s[32:35], s75 offen offset:1024 nt
    s_waitcnt vmcnt(3)
    buffer_load_dwordx4 v[200:203], v1, s[32:35], s75 offen offset:2048 nt
    s_waitcnt vmcnt(3)
    buffer_load_dwordx4 v[204:207], v1, s[32:35], s75 offen offset:3072 nt
    s_waitcnt vmcnt(3)
    buffer_load_dwordx4 v[208:211], v1, s[36:39], s75 offen offset:0 nt
    s_waitcnt vmcnt(3)
    buffer_load_dwordx4 v[212:215], v1, s[36:39], s75 offen offset:1024 nt
    s_waitcnt vmcnt(3)
    buffer_load_dwordx4 v[216:219], v1, s[36:39], s75 offen offset:2048 nt
    s_waitcnt vmcnt(3)
    buffer_load_dwordx4 v[220:223], v1, s[36:39], s75 offen offset:3072 nt
L_slot4:
    ds_read_b32 v7, v4 offset:4
    s_waitcnt lgkmcnt(0)
    v_readfirstlane_b32 s80, v7
    s_nop 0
    s_cmp_lg_u32 s80, 0
    s_cbranch_scc1 L_qready
    s_mov_b64 exec, 1
    ds_add_rtn_u32 v5, v4, v6
    s_mov_b64 exec, -1
    s_waitcnt lgkmcnt(0)
    v_readfirstlane_b32 s79, v5
    s_nop 0
    s_mul_i32 s75, s79, s87
    s_add_u32 s75, s75, s3
    s_bitset1_b32 s74, 4
    s_waitcnt vmcnt(3)
    buffer_load_dwordx4 v[224:227], v1, s[32:35], s75 offen offset:0 nt
    s_waitcnt vmcnt(3)
    buffer_load_dwordx4 v[228:231], v1, s[32:35], s75 offen offset:1024 nt
    s_waitcnt vmcnt(3)
    buffer_load_dwordx4 v[232:235], v1, s[32:35], s75 offen offset:2048 nt
    s_waitcnt vmcnt(3)
    buffer_load_dwordx4 v[236:239], v1, s[32:35], s75 offen offset:3072 nt
    s_waitcnt vmcnt(3)
    buffer_load_dwordx4 v[240:243], v1, s[36:39], s75 offen offset:0 nt
    s_waitcnt vmcnt(3)
    buffer_load_dwordx4 v[244:247], v1, s[36:39], s75 offen offset:1024 nt
    s_waitcnt vmcnt(3)
    buffer_load_dwordx4 v[248:251], v1, s[36:39], s75 offen offset:2048 nt
    s_waitcnt vmcnt(3)
    buffer_load_dwordx4 v[252:255], v1, s[36:39], s75 offen offset:3072 nt
L_slot5:
    ds_read_b32 v7, v4 offset:4
    s_waitcnt lgkmcnt(0)
    v_readfirstlane_b32 s80, v7
    s_nop 0
    s_cmp_lg_u32 s80, 0
    s_cbranch_scc1 L_qready
    s_mov_b64 exec, 1
    ds_add_rtn_u32 v5, v4, v6
    s_mov_b64 exec, -1
    s_waitcnt lgkmcnt(0)
    v_readfirstlane_b32 s79, v5
    s_nop 0
    s_mul_i32 s75, s79, s87
    s_add_u32 s75, s75, s3
    s_bitset1_b32 s74, 5
    s_add_u32 m0, s55, 0
    s_waitcnt vmcnt(3)
    buffer_load_dwordx4 v1, s[32:35], s75 offen offset:0 nt lds
    s_add_u32 m0, s55, 0
    s_waitcnt vmcnt(3)
    buffer_load_dwordx4 v1, s[32:35], s75 offen offset:1024 nt lds
    s_add_u32 m0, s55, 0
    s_waitcnt vmcnt(3)
    buffer_load_dwordx4 v1, s[32:35], s75 offen offset:2048 nt lds
    s_add_u32 m0, s55, 0
    s_waitcnt vmcnt(3)
    buffer_load_dwordx4 v1, s[32:35], s75 offen offset:3072 nt lds
    s_add_u32 m0, s55, 4096
    s_waitcnt vmcnt(3)
    buffer_load_dwordx4 v1, s[36:39], s75 offen offset:0 nt lds
    s_add_u32 m0, s55, 4096
    s_waitcnt vmcnt(3)
    buffer_load_dwordx4 v1, s[36:39], s75 offen offset:1024 nt lds
    s_add_u32 m0, s55, 4096
    s_waitcnt vmcnt(3)
    buffer_load_dwordx4 v1, s[36:39], s75 offen offset:2048 nt lds
    s_add_u32 m0, s55, 4096
    s_waitcnt vmcnt(3)
    buffer_load_dwordx4 v1, s[36:39], s75 offen offset:3072 nt lds
    s_mov_b32 s77, 6400000
L_qwait:
    ds_read_b32 v7, v4 offset:4
    s_waitcnt lgkmcnt(0)
    v_readfirstlane_b32 s80, v7
    s_nop 0
    s_cmp_lg_u32 s80, 0
    s_cbranch_scc1 L_qready
    s_sub_u32 s77, s77, 1
    s_cbranch_scc1 L_qready
    s_sleep 1
    s_branch L_qwait
L_walk:
    s_cmp_ge_u32 s76, s14
    s_cbranch_scc1 L_walkout
    s_mov_b64 exec, 0
    s_cmp_eq_u32 s76, 0
    s_cbranch_scc1 L_pad0
    s_cmp_eq_u32 s76, 1
    s_cbranch_scc1 L_pad1
    s_cmp_eq_u32 s76, 2
    s_cbranch_scc1 L_pad2
    s_cmp_eq_u32 s76, 3
    s_cbranch_scc1 L_pad3
    s_cmp_eq_u32 s76, 4
    s_cbranch_scc1 L_pad4
    s_cmp_eq_u32 s76, 5
    s_cbranch_scc1 L_pad5
    s_cmp_eq_u32 s76, 6
    s_cbranch_scc1 L_pad6
    s_cmp_eq_u32 s76, 7
    s_cbranch_scc1 L_pad7
    s_cmp_eq_u32 s76, 8
    s_cbranch_scc1 L_pad8
    s_cmp_eq_u32 s76, 9
    s_cbranch_scc1 L_pad9
    s_cmp_eq_u32 s76, 10
    s_cbranch_scc1 L_pad10
    s_cmp_eq_u32 s76, 11
    s_cbranch_scc1 L_pad11
    s_cmp_eq_u32 s76, 12
    s_cbranch_scc1 L_pad12
    s_cmp_eq_u32 s76, 13
    s_cbranch_scc1 L_pad13
    s_cmp_eq_u32 s76, 14
    s_cbranch_scc1 L_pad14
    s_cmp_eq_u32 s76, 15
    s_cbranch_scc1 L_pad15
    s_cmp_eq_u32 s76, 16
    s_cbranch_scc1 L_pad16
    s_cmp_eq_u32 s76, 17
    s_cbranch_scc1 L_pad17
    s_cmp_eq_u32 s76, 18
    s_cbranch_scc1 L_pad18
    s_cmp_eq_u32 s76, 19
    s_cbranch_scc1 L_pad19
    s_cmp_eq_u32 s76, 20
    s_cbranch_scc1 L_pad20
    s_cmp_eq_u32 s76, 21
    s_cbranch_scc1 L_pad21
    s_cmp_eq_u32 s76, 22
    s_cbranch_scc1 L_pad22
    s_cmp_eq_u32 s76, 23
    s_cbranch_scc1 L_pad23
    s_cmp_eq_u32 s76, 24
    s_cbranch_scc1 L_pad24
    s_cmp_eq_u32 s76, 25
    s_cbranch_scc1 L_pad25
    s_cmp_eq_u32 s76, 26
    s_cbranch_scc1 L_pad26
    s_cmp_eq_u32 s76, 27
    s_cbranch_scc1 L_pad27
    s_cmp_eq_u32 s76, 28
    s_cbranch_scc1 L_pad28
    s_cmp_eq_u32 s76, 29
    s_cbranch_scc1 L_pad29
    s_cmp_eq_u32 s76, 30
    s_cbranch_scc1 L_pad30
    s_cmp_eq_u32 s76, 31
    s_cbranch_scc1 L_pad31
    s_cmp_eq_u32 s76, 32
    s_cbranch_scc1 L_pad32
L_walkret:
    s_mov_b64 exec, -1
    s_add_u32 s76, s76, s15
L_walkout:
    s_setpc_b64 s[90:91]
L_qready:
L_pad0:
    s_cbranch_execz L_walkret
    s_mul_i32 s56, s57, 0x9e3779b1
    s_add_u32 s56, s56, 0x7f4a7c15
    s_andn2_b32 s56, s56, 0xff
    s_and_b32 s54, s57, 0xff
    s_cmp_eq_u32 s54, 0xff
    s_cselect_b32 s54, 0, s54
    s_add_u32 s54, s54, 1
    s_or_b32 s56, s56, s54
    s_mov_b32 s40, s12
    s_mov_b32 s41, s13
    s_mov_b32 s42, 4718592
    s_mov_b32 s43, 0x20000
    s_add_u32 s76, s64, 18
    s_mov_b32 s14, 33
    s_mov_b32 s15, 8
    v_and_b32 v7, 15, v0
    v_lshlrev_b32 v7, 4, v7
    ds_read_b128 v[8:11], v7 offset:14848
    ds_read_b128 v[12:15], v7 offset:15104
    v_mov_b32 v16, 0
    v_mov_b32 v17, 0
    v_mov_b32 v18, 0
    v_mov_b32 v19, 0
    v_mov_b32 v20, 0
    v_mov_b32 v21, 0
    v_mov_b32 v22, 0
    v_mov_b32 v23, 0
    v_mov_b32 v24, 0
    v_mov_b32 v25, 0
    v_mov_b32 v26, 0
    v_mov_b32 v27, 0
    v_mov_b32 v28, 0
    v_mov_b32 v29, 0
    v_mov_b32 v30, 0
    v_mov_b32 v31, 0
    v_mov_b32 v32, 0xff800000
    v_mov_b32 v33, 0xff800000
    v_mov_b32 v34, 0
    v_mov_b32 v35, 0
    s_mov_b32 s72, 0
    s_lshl_b32 s79, s65, 4
    s_add_u32 s79, s79, s66
    s_lshl_b32 s79, s79, 7
    s_add_u32 s79, s79, 262144
    v_mov_b32 v7, s79
    s_waitcnt vmcnt(3) lgkmcnt(0)
L_loop:
    s_mov_b64 exec, 1
    ds_add_rtn_u32 v5, v4, v6
    ds_read_b32 v60, v4 offset:16
    s_mov_b64 exec, -1
    s_waitcnt vmcnt(4)
    s_cmp_eq_u32 s73, 0
    s_cbranch_scc1 L_skip
    v_dot2_f32_bf16 v36, v64, v8, 0
    v_dot2_f32_bf16 v37, v64, v12, 0
    v_dot2_f32_bf16 v38, v68, v8, 0
    v_dot2_f32_bf16 v39, v68, v12, 0
    v_dot2_f32_bf16 v40, v72, v8, 0
    v_dot2_f32_bf16 v41, v72, v12, 0
    v_dot2_f32_bf16 v42, v76, v8, 0
    v_dot2_f32_bf16 v43, v76, v12, 0
    v_dot2_f32_bf16 v36, v65, v9, v36
    v_dot2_f32_bf16 v37, v65, v13, v37
    v_dot2_f32_bf16 v38, v69, v9, v38
    v_dot2_f32_bf16 v39, v69, v13, v39
    v_dot2_f32_bf16 v40, v73, v9, v40
    v_dot2_f32_bf16 v41, v73, v13, v41
    v_dot2_f32_bf16 v42, v77, v9, v42
    v_dot2_f32_bf16 v43, v77, v13, v43
    v_dot2_f32_bf16 v36, v66, v10, v36
    v_dot2_f32_bf16 v37, v66, v14, v37
L_pad1:
    s_cbranch_execz L_walkret
    v_dot2_f32_bf16 v38, v70, v10, v38
    v_dot2_f32_bf16 v39, v70, v14, v39
    v_dot2_f32_bf16 v40, v74, v10, v40
    v_dot2_f32_bf16 v41, v74, v14, v41
    v_dot2_f32_bf16 v42, v78, v10, v42
    v_dot2_f32_bf16 v43, v78, v14, v43
    v_dot2_f32_bf16 v36, v67, v11, v36
    v_dot2_f32_bf16 v37, v67, v15, v37
    v_dot2_f32_bf16 v38, v71, v11, v38
    v_dot2_f32_bf16 v39, v71, v15, v39
    v_dot2_f32_bf16 v40, v75, v11, v40
    v_dot2_f32_bf16 v41, v75, v15, v41
    v_dot2_f32_bf16 v42, v79, v11, v42
    v_dot2_f32_bf16 v43, v79, v15, v43
    s_waitcnt lgkmcnt(0)
    v_readfirstlane_b32 s79, v5
    v_readfirstlane_b32 s80, v60
    s_mul_i32 s75, s79, s87
    s_add_u32 s75, s75, s3
    s_mov_b32 s83, 1
    s_cmp_lt_u32 s79, s80
    s_cbranch_scc1 L_goka
    s_call_b64 s[88:89], L_gslow
L_goka:
    s_sub_u32 s80, s79, 88
    s_and_b32 s81, s80, 2147483651
    s_cbranch_scc1 L_gnca
    s_call_b64 s[88:89], L_claim
L_gnca:
    buffer_load_dwordx4 v[64:67], v1, s[32:35], s75 offen offset:0 nt
    buffer_load_dwordx4 v[68:71], v1, s[32:35], s75 offen offset:1024 nt
    buffer_load_dwordx4 v[72:75], v1, s[32:35], s75 offen offset:2048 nt
    buffer_load_dwordx4 v[76:79], v1, s[32:35], s75 offen offset:3072 nt
    v_add_f32_dpp v44, v36, v36 row_ror:8 row_mask:0xf bank_mask:0x3
    v_add_f32_dpp v45, v38, v38 row_ror:8 row_mask:0xf bank_mask:0x3
    v_add_f32_dpp v46, v37, v37 row_ror:8 row_mask:0xf bank_mask:0x3
    v_add_f32_dpp v47, v39, v39 row_ror:8 row_mask:0xf bank_mask:0x3
    v_add_f32_dpp v44, v40, v40 row_ror:8 row_mask:0xf bank_mask:0xc
    v_add_f32_dpp v45, v42, v42 row_ror:8 row_mask:0xf bank_mask:0xc
    v_add_f32_dpp v46, v41, v41 row_ror:8 row_mask:0xf bank_mask:0xc
    v_add_f32_dpp v47, v43, v43 row_ror:8 row_mask:0xf bank_mask:0xc
    v_add_f32_dpp v48, v44, v44 row_half_mirror row_mask:0xf bank_mask:0x5
    v_add_f32_dpp v49, v46, v46 row_half_mirror row_mask:0xf bank_mask:0x5
    s_nop 0
    v_add_f32_dpp v48, v45, v45 row_half_mirror row_mask:0xf bank_mask:0xa
    v_add_f32_dpp v49, v47, v47 row_half_mirror row_mask:0xf bank_mask:0xa
    s_nop 0
    v_add_f32_dpp v48, v48, v48 quad_perm:[1,0,3,2] row_mask:0xf bank_mask:0xf
    v_add_f32_dpp v49, v49, v49 quad_perm:[1,0,3,2] row_mask:0xf bank_mask:0xf
    s_nop 0
    v_add_f32_dpp v48, v48, v48 quad_perm:[2,3,0,1] row_mask:0xf bank_mask:0xf
    v_add_f32_dpp v49, v49, v49 quad_perm:[2,3,0,1] row_mask:0xf bank_mask:0xf
    v_cvt_pk_bf16_f32 v44, v48, v49
    v_lshlrev_b32 v48, 16, v44
    v_and_b32 v49, s69, v44
    v_mul_f32 v48, s71, v48
    v_mul_f32 v49, s71, v49
    v_cvt_pk_bf16_f32 v44, v48, v49
    v_lshlrev_b32 v48, 16, v44
    v_and_b32 v49, s69, v44
    v_mul_f32 v48, s70, v48
    v_mul_f32 v49, s70, v49
    s_nop 0
    v_max_f32_dpp v44, v48, v48 row_ror:4 row_mask:0xf bank_mask:0xf
    v_max_f32_dpp v45, v49, v49 row_ror:4 row_mask:0xf bank_mask:0xf
    s_nop 0
    v_max_f32_dpp v46, v44, v44 row_ror:8 row_mask:0xf bank_mask:0xf
    v_max_f32_dpp v47, v45, v45 row_ror:8 row_mask:0xf bank_mask:0xf
    v_max_f32 v44, v46, v32
    v_max_f32 v45, v47, v33
    v_sub_f32 v50, v32, v44
    v_sub_f32 v51, v33, v45
L_pad2:
    s_cbranch_execz L_walkret
    v_sub_f32 v48, v48, v44
    v_sub_f32 v49, v49, v45
    v_exp_f32 v48, v48
    v_exp_f32 v49, v49
    v_exp_f32 v50, v50
    v_exp_f32 v51, v51
    v_mov_b32 v32, v44
    v_mov_b32 v33, v45
    v_mov_b32_dpp v36, v48 row_newbcast:0 row_mask:0xf bank_mask:0xf
    v_mov_b32_dpp v37, v49 row_newbcast:0 row_mask:0xf bank_mask:0xf
    v_mov_b32_dpp v38, v48 row_newbcast:4 row_mask:0xf bank_mask:0xf
    v_mov_b32_dpp v39, v49 row_newbcast:4 row_mask:0xf bank_mask:0xf
    v_mov_b32_dpp v40, v48 row_newbcast:8 row_mask:0xf bank_mask:0xf
    v_mov_b32_dpp v41, v49 row_newbcast:8 row_mask:0xf bank_mask:0xf
    v_mov_b32_dpp v42, v48 row_newbcast:12 row_mask:0xf bank_mask:0xf
    v_mov_b32_dpp v43, v49 row_newbcast:12 row_mask:0xf bank_mask:0xf
    v_fma_f32 v34, v34, v50, v48
    v_fma_f32 v35, v35, v51, v49
    v_pk_mul_f32 v[16:17], v[16:17], v[50:51] op_sel:[0,0] op_sel_hi:[1,0]
    v_pk_mul_f32 v[18:19], v[18:19], v[50:51] op_sel:[0,0] op_sel_hi:[1,0]
    v_pk_mul_f32 v[20:21], v[20:21], v[50:51] op_sel:[0,0] op_sel_hi:[1,0]
    v_pk_mul_f32 v[22:23], v[22:23], v[50:51] op_sel:[0,0] op_sel_hi:[1,0]
    v_pk_mul_f32 v[24:25], v[24:25], v[50:51] op_sel:[0,1] op_sel_hi:[1,1]
    v_pk_mul_f32 v[26:27], v[26:27], v[50:51] op_sel:[0,1] op_sel_hi:[1,1]
    v_pk_mul_f32 v[28:29], v[28:29], v[50:51] op_sel:[0,1] op_sel_hi:[1,1]
    v_pk_mul_f32 v[30:31], v[30:31], v[50:51] op_sel:[0,1] op_sel_hi:[1,1]
    s_waitcnt vmcnt(4)
    s_cmp_eq_u32 s86, 0
    s_cbranch_scc1 L_nocl
    s_call_b64 s[88:89], L_claimdone
L_nocl:
    v_lshlrev_b32 v52, 16, v80
    v_and_b32 v53, s69, v80
    v_lshlrev_b32 v54, 16, v81
    v_and_b32 v55, s69, v81
    v_lshlrev_b32 v56, 16, v82
    v_and_b32 v57, s69, v82
    v_lshlrev_b32 v58, 16, v83
    v_and_b32 v59, s69, v83
    v_pk_fma_f32 v[16:17], v[52:53], v[36:37], v[16:17] op_sel:[0,0,0] op_sel_hi:[1,0,1]
    v_pk_fma_f32 v[24:25], v[52:53], v[36:37], v[24:25] op_sel:[0,1,0] op_sel_hi:[1,1,1]
    v_pk_fma_f32 v[18:19], v[54:55], v[36:37], v[18:19] op_sel:[0,0,0] op_sel_hi:[1,0,1]
    v_pk_fma_f32 v[26:27], v[54:55], v[36:37], v[26:27] op_sel:[0,1,0] op_sel_hi:[1,1,1]
    v_pk_fma_f32 v[20:21], v[56:57], v[36:37], v[20:21] op_sel:[0,0,0] op_sel_hi:[1,0,1]
    v_pk_fma_f32 v[28:29], v[56:57], v[36:37], v[28:29] op_sel:[0,1,0] op_sel_hi:[1,1,1]
    v_pk_fma_f32 v[22:23], v[58:59], v[36:37], v[22:23] op_sel:[0,0,0] op_sel_hi:[1,0,1]
    v_pk_fma_f32 v[30:31], v[58:59], v[36:37], v[30:31] op_sel:[0,1,0] op_sel_hi:[1,1,1]
    v_lshlrev_b32 v52, 16, v84
    v_and_b32 v53, s69, v84
    v_lshlrev_b32 v54, 16, v85
    v_and_b32 v55, s69, v85
    v_lshlrev_b32 v56, 16, v86
    v_and_b32 v57, s69, v86
    v_lshlrev_b32 v58, 16, v87
    v_and_b32 v59, s69, v87
    v_pk_fma_f32 v[16:17], v[52:53], v[38:39], v[16:17] op_sel:[0,0,0] op_sel_hi:[1,0,1]
    v_pk_fma_f32 v[24:25], v[52:53], v[38:39], v[24:25] op_sel:[0,1,0] op_sel_hi:[1,1,1]
    v_pk_fma_f32 v[18:19], v[54:55], v[38:39], v[18:19] op_sel:[0,0,0] op_sel_hi:[1,0,1]
    v_pk_fma_f32 v[26:27], v[54:55], v[38:39], v[26:27] op_sel:[0,1,0] op_sel_hi:[1,1,1]
    v_pk_fma_f32 v[20:21], v[56:57], v[38:39], v[20:21] op_sel:[0,0,0] op_sel_hi:[1,0,1]
    v_pk_fma_f32 v[28:29], v[56:57], v[38:39], v[28:29] op_sel:[0,1,0] op_sel_hi:[1,1,1]
    v_pk_fma_f32 v[22:23], v[58:59], v[38:39], v[22:23] op_sel:[0,0,0] op_sel_hi:[1,0,1]
    v_pk_fma_f32 v[30:31], v[58:59], v[38:39], v[30:31] op_sel:[0,1,0] op_sel_hi:[1,1,1]
    v_lshlrev_b32 v52, 16, v88
    v_and_b32 v53, s69, v88
    v_lshlrev_b32 v54, 16, v89
L_pad3:
    s_cbranch_execz L_walkret
    v_and_b32 v55, s69, v89
    v_lshlrev_b32 v56, 16, v90
    v_and_b32 v57, s69, v90
    v_lshlrev_b32 v58, 16, v91
    v_and_b32 v59, s69, v91
    v_pk_fma_f32 v[16:17], v[52:53], v[40:41], v[16:17] op_sel:[0,0,0] op_sel_hi:[1,0,1]
    v_pk_fma_f32 v[24:25], v[52:53], v[40:41], v[24:25] op_sel:[0,1,0] op_sel_hi:[1,1,1]
    v_pk_fma_f32 v[18:19], v[54:55], v[40:41], v[18:19] op_sel:[0,0,0] op_sel_hi:[1,0,1]
    v_pk_fma_f32 v[26:27], v[54:55], v[40:41], v[26:27] op_sel:[0,1,0] op_sel_hi:[1,1,1]
    v_pk_fma_f32 v[20:21], v[56:57], v[40:41], v[20:21] op_sel:[0,0,0] op_sel_hi:[1,0,1]
    v_pk_fma_f32 v[28:29], v[56:57], v[40:41], v[28:29] op_sel:[0,1,0] op_sel_hi:[1,1,1]
    v_pk_fma_f32 v[22:23], v[58:59], v[40:41], v[22:23] op_sel:[0,0,0] op_sel_hi:[1,0,1]
    v_pk_fma_f32 v[30:31], v[58:59], v[40:41], v[30:31] op_sel:[0,1,0] op_sel_hi:[1,1,1]
    v_lshlrev_b32 v52, 16, v92
    v_and_b32 v53, s69, v92
    v_lshlrev_b32 v54, 16, v93
    v_and_b32 v55, s69, v93
    v_lshlrev_b32 v56, 16, v94
    v_and_b32 v57, s69, v94
    v_lshlrev_b32 v58, 16, v95
    v_and_b32 v59, s69, v95
    v_pk_fma_f32 v[16:17], v[52:53], v[42:43], v[16:17] op_sel:[0,0,0] op_sel_hi:[1,0,1]
    v_pk_fma_f32 v[24:25], v[52:53], v[42:43], v[24:25] op_sel:[0,1,0] op_sel_hi:[1,1,1]
    v_pk_fma_f32 v[18:19], v[54:55], v[42:43], v[18:19] op_sel:[0,0,0] op_sel_hi:[1,0,1]
    v_pk_fma_f32 v[26:27], v[54:55], v[42:43], v[26:27] op_sel:[0,1,0] op_sel_hi:[1,1,1]
    v_pk_fma_f32 v[20:21], v[56:57], v[42:43], v[20:21] op_sel:[0,0,0] op_sel_hi:[1,0,1]
    v_pk_fma_f32 v[28:29], v[56:57], v[42:43], v[28:29] op_sel:[0,1,0] op_sel_hi:[1,1,1]
    v_pk_fma_f32 v[22:23], v[58:59], v[42:43], v[22:23] op_sel:[0,0,0] op_sel_hi:[1,0,1]
    v_pk_fma_f32 v[30:31], v[58:59], v[42:43], v[30:31] op_sel:[0,1,0] op_sel_hi:[1,1,1]
L_join:
    buffer_load_dwordx4 v[80:83], v1, s[36:39], s75 offen offset:0 nt
    buffer_load_dwordx4 v[84:87], v1, s[36:39], s75 offen offset:1024 nt
    buffer_load_dwordx4 v[88:91], v1, s[36:39], s75 offen offset:2048 nt
    buffer_load_dwordx4 v[92:95], v1, s[36:39], s75 offen offset:3072 nt
    s_mov_b32 s73, s83
    s_cmp_ge_u32 s72, 3
    s_cbranch_scc0 L_extra
L_next:
    s_call_b64 s[90:91], L_walk
    s_cmp_lg_u32 s73, 0
    s_cbranch_scc1 L_loop
    s_branch L_tail
L_skip:
    s_waitcnt lgkmcnt(0)
    v_readfirstlane_b32 s79, v5
    v_readfirstlane_b32 s80, v60
    s_mul_i32 s75, s79, s87
    s_add_u32 s75, s75, s3
    s_mov_b32 s83, 1
    s_cmp_lt_u32 s79, s80
    s_cbranch_scc1 L_gokb
    s_call_b64 s[88:89], L_gslow
L_gokb:
    s_sub_u32 s80, s79, 88
    s_and_b32 s81, s80, 2147483651
    s_cbranch_scc1 L_gncb
    s_call_b64 s[88:89], L_claim
L_gncb:
    buffer_load_dwordx4 v[64:67], v1, s[32:35], s75 offen offset:0 nt
    buffer_load_dwordx4 v[68:71], v1, s[32:35], s75 offen offset:1024 nt
    buffer_load_dwordx4 v[72:75], v1, s[32:35], s75 offen offset:2048 nt
    buffer_load_dwordx4 v[76:79], v1, s[32:35], s75 offen offset:3072 nt
    s_waitcnt vmcnt(4)
    s_cmp_eq_u32 s86, 0
    s_cbranch_scc1 L_join
    s_call_b64 s[88:89], L_claimdone
    s_branch L_join
L_gslow:
    s_mov_b32 s77, 6400000
L_gs2:
    ds_read_b96 v[60:62], v4 offset:16
    s_waitcnt lgkmcnt(0)
    v_readfirstlane_b32 s80, v60
    v_readfirstlane_b32 s81, v61
    v_readfirstlane_b32 s82, v62
    s_cmp_lt_u32 s79, s80
    s_cbranch_scc1 L_gs4
    s_sub_u32 s77, s77, 1
    s_cbranch_scc1 L_gs3
    s_xor_b32 s81, s81, 0x10000
    s_cmp_lg_u32 s81, s82
    s_cbranch_scc1 L_gs2
L_gs3:
    ds_read_b32 v60, v4 offset:16
    s_waitcnt lgkmcnt(0)
L_pad4:
    s_cbranch_execz L_walkret
    v_readfirstlane_b32 s80, v60
    s_nop 0
    s_cmp_lt_u32 s79, s80
    s_cbranch_scc1 L_gs4
    s_mov_b32 s83, 0
    s_mov_b32 s75, 0x100000
L_gs4:
    s_setpc_b64 s[88:89]
L_claim:
    s_mov_b64 exec, 1
    ds_add_rtn_u32 v60, v4, v6 offset:20
    v_mov_b32 v62, 4
    v_mov_b32 v63, 0
    s_waitcnt lgkmcnt(0)
    v_readfirstlane_b32 s81, v60
    s_nop 0
    s_cmp_ge_u32 s81, 0x10000
    s_cbranch_scc1 L_clskip
    global_atomic_add_x2 v[2:3], v7, v[62:63], s[28:29] sc0 sc1
    s_mov_b64 exec, -1
    s_mov_b32 s86, 1
    s_setpc_b64 s[88:89]
L_clskip:
    ds_add_u32 v4, v6 offset:24
    s_mov_b64 exec, -1
    s_setpc_b64 s[88:89]
L_claimdone:
    v_readfirstlane_b32 s80, v2
    v_readfirstlane_b32 s81, v3
    v_mov_b32 v62, 4
    v_mov_b32 v63, 0x10000
    s_mov_b32 s86, 0
    s_mov_b64 exec, 1
    s_cmp_lg_u32 s81, s56
    s_cbranch_scc1 L_cdeny
    s_cmp_ge_u32 s80, 64
    s_cbranch_scc1 L_cdeny
    ds_add_u32 v4, v62 offset:16
    s_branch L_cres
L_cdeny:
    ds_or_b32 v4, v63 offset:20
L_cres:
    ds_add_u32 v4, v6 offset:24
    s_mov_b64 exec, -1
    s_setpc_b64 s[88:89]
L_extra:
    s_cmp_lg_u32 s72, 0
    s_cbranch_scc1 L_ex1
    s_bitcmp1_b32 s74, 4
    s_cbranch_scc0 L_xs_1
    s_call_b64 s[88:89], L_pw
L_xs_1:
    s_bitcmp1_b32 s74, 0
    s_cbranch_scc0 L_xs_2
    v_mov_b64 v[224:225], v[96:97]
    v_mov_b64 v[226:227], v[98:99]
    v_mov_b64 v[228:229], v[100:101]
    v_mov_b64 v[230:231], v[102:103]
    v_mov_b64 v[232:233], v[104:105]
    v_mov_b64 v[234:235], v[106:107]
    v_mov_b64 v[236:237], v[108:109]
    v_mov_b64 v[238:239], v[110:111]
    v_mov_b64 v[240:241], v[112:113]
    v_mov_b64 v[242:243], v[114:115]
    v_mov_b64 v[244:245], v[116:117]
    v_mov_b64 v[246:247], v[118:119]
    v_mov_b64 v[248:249], v[120:121]
    v_mov_b64 v[250:251], v[122:123]
    v_mov_b64 v[252:253], v[124:125]
    v_mov_b64 v[254:255], v[126:127]
    s_call_b64 s[88:89], L_pw
L_xs_2:
    s_mov_b32 s72, 1
    s_branch L_loop
L_ex1:
    s_cmp_lg_u32 s72, 1
    s_cbranch_scc1 L_ex2
    s_bitcmp1_b32 s74, 1
    s_cbranch_scc0 L_xs_3
    v_mov_b64 v[224:225], v[128:129]
    v_mov_b64 v[226:227], v[130:131]
    v_mov_b64 v[228:229], v[132:133]
    v_mov_b64 v[230:231], v[134:135]
    v_mov_b64 v[232:233], v[136:137]
    v_mov_b64 v[234:235], v[138:139]
    v_mov_b64 v[236:237], v[140:141]
    v_mov_b64 v[238:239], v[142:143]
    v_mov_b64 v[240:241], v[144:145]
    v_mov_b64 v[242:243], v[146:147]
    v_mov_b64 v[244:245], v[148:149]
    v_mov_b64 v[246:247], v[150:151]
L_pad5:
    s_cbranch_execz L_walkret
    v_mov_b64 v[248:249], v[152:153]
    v_mov_b64 v[250:251], v[154:155]
    v_mov_b64 v[252:253], v[156:157]
    v_mov_b64 v[254:255], v[158:159]
    s_call_b64 s[88:89], L_pw
L_xs_3:
    s_bitcmp1_b32 s74, 2
    s_cbranch_scc0 L_xs_4
    v_mov_b64 v[224:225], v[160:161]
    v_mov_b64 v[226:227], v[162:163]
    v_mov_b64 v[228:229], v[164:165]
    v_mov_b64 v[230:231], v[166:167]
    v_mov_b64 v[232:233], v[168:169]
    v_mov_b64 v[234:235], v[170:171]
    v_mov_b64 v[236:237], v[172:173]
    v_mov_b64 v[238:239], v[174:175]
    v_mov_b64 v[240:241], v[176:177]
    v_mov_b64 v[242:243], v[178:179]
    v_mov_b64 v[244:245], v[180:181]
    v_mov_b64 v[246:247], v[182:183]
    v_mov_b64 v[248:249], v[184:185]
    v_mov_b64 v[250:251], v[186:187]
    v_mov_b64 v[252:253], v[188:189]
    v_mov_b64 v[254:255], v[190:191]
    s_call_b64 s[88:89], L_pw
L_xs_4:
    s_mov_b32 s72, 2
    s_branch L_loop
L_ex2:
    s_bitcmp1_b32 s74, 3
    s_cbranch_scc0 L_xs_5
    v_mov_b64 v[224:225], v[192:193]
    v_mov_b64 v[226:227], v[194:195]
    v_mov_b64 v[228:229], v[196:197]
    v_mov_b64 v[230:231], v[198:199]
    v_mov_b64 v[232:233], v[200:201]
    v_mov_b64 v[234:235], v[202:203]
    v_mov_b64 v[236:237], v[204:205]
    v_mov_b64 v[238:239], v[206:207]
    v_mov_b64 v[240:241], v[208:209]
    v_mov_b64 v[242:243], v[210:211]
    v_mov_b64 v[244:245], v[212:213]
    v_mov_b64 v[246:247], v[214:215]
    v_mov_b64 v[248:249], v[216:217]
    v_mov_b64 v[250:251], v[218:219]
    v_mov_b64 v[252:253], v[220:221]
    v_mov_b64 v[254:255], v[222:223]
    s_call_b64 s[88:89], L_pw
L_xs_5:
    s_bitcmp1_b32 s74, 5
    s_cbranch_scc0 L_xs_6
    v_add_u32 v60, s55, v1
    ds_read_b128 v[224:227], v60 offset:0
    ds_read_b128 v[228:231], v60 offset:1024
    ds_read_b128 v[232:235], v60 offset:2048
    ds_read_b128 v[236:239], v60 offset:3072
    ds_read_b128 v[240:243], v60 offset:4096
    ds_read_b128 v[244:247], v60 offset:5120
    ds_read_b128 v[248:251], v60 offset:6144
    ds_read_b128 v[252:255], v60 offset:7168
    s_waitcnt lgkmcnt(0)
    s_call_b64 s[88:89], L_pw
L_xs_6:
    s_mov_b32 s72, 3
    v_lshrrev_b32 v118, 5, v0
    v_lshlrev_b32 v117, 9, v118
    v_and_b32 v119, 15, v0
    v_lshl_add_u32 v117, v119, 5, v117
    v_bfe_u32 v119, v0, 4, 1
    v_lshl_add_u32 v117, v119, 4, v117
    s_lshl_b32 s80, s64, 10
    v_add_u32 v117, s80, v117
    s_lshl_b32 s80, s64, 3
    v_lshl_add_u32 v118, v118, 6, s80
    v_lshrrev_b32 v120, 3, v0
    v_mul_u32_u24 v120, 1152, v120
L_pad6:
    s_cbranch_execz L_walkret
    v_and_b32 v119, 7, v0
    v_bfe_u32 v121, v0, 4, 1
    v_lshlrev_b32 v121, 1, v121
    v_xor_b32 v119, v119, v121
    v_lshl_add_u32 v120, v119, 4, v120
    v_xor_b32 v121, 64, v120
    s_mul_i32 s84, s78, 7282
    s_lshr_b32 s84, s84, 16
    s_mul_i32 s80, s84, 9
    s_sub_u32 s80, s78, s80
    s_lshl_b32 s84, s84, 3
    s_add_u32 s84, s84, s64
    s_mul_i32 s84, s84, 36864
    s_lshl_b32 s80, s80, 7
    s_add_u32 s84, s84, s80
    s_cmp_ge_u32 s53, 72
    s_cbranch_scc1 L_next
    s_mul_i32 s80, s64, 13824
    v_lshl_add_u32 v116, v0, 3, s80
    s_add_u32 s30, s28, 13312
    s_addc_u32 s31, s29, 0
    v_mov_b32 v104, 0
    v_mov_b32 v105, s56
    global_load_dwordx2 v[96:97], v116, s[30:31] offset:-2304 sc1
    global_load_dwordx2 v[98:99], v116, s[30:31] offset:-1792 sc1
    global_load_dwordx2 v[100:101], v116, s[30:31] offset:-1280 sc1
    global_load_dwordx2 v[102:103], v116, s[30:31] offset:-768 sc1
    s_mov_b32 exec_hi, 0
    global_load_dwordx2 v[104:105], v116, s[30:31] offset:-256 sc1
    s_mov_b64 exec, -1
    v_mov_b32 v114, 0
    v_mov_b32 v115, s56
    global_load_dwordx2 v[106:107], v116, s[30:31] offset:0 sc1
    global_load_dwordx2 v[108:109], v116, s[30:31] offset:512 sc1
    global_load_dwordx2 v[110:111], v116, s[30:31] offset:1024 sc1
    global_load_dwordx2 v[112:113], v116, s[30:31] offset:1536 sc1
    s_mov_b32 exec_hi, 0
    global_load_dwordx2 v[114:115], v116, s[30:31] offset:2048 sc1
    s_mov_b64 exec, -1
    s_branch L_next
L_pw:
    v_dot2_f32_bf16 v36, v224, v8, 0
    v_dot2_f32_bf16 v37, v224, v12, 0
    v_dot2_f32_bf16 v38, v228, v8, 0
    v_dot2_f32_bf16 v39, v228, v12, 0
    v_dot2_f32_bf16 v40, v232, v8, 0
    v_dot2_f32_bf16 v41, v232, v12, 0
    v_dot2_f32_bf16 v42, v236, v8, 0
    v_dot2_f32_bf16 v43, v236, v12, 0
    v_dot2_f32_bf16 v36, v225, v9, v36
    v_dot2_f32_bf16 v37, v225, v13, v37
    v_dot2_f32_bf16 v38, v229, v9, v38
    v_dot2_f32_bf16 v39, v229, v13, v39
    v_dot2_f32_bf16 v40, v233, v9, v40
    v_dot2_f32_bf16 v41, v233, v13, v41
    v_dot2_f32_bf16 v42, v237, v9, v42
    v_dot2_f32_bf16 v43, v237, v13, v43
    v_dot2_f32_bf16 v36, v226, v10, v36
    v_dot2_f32_bf16 v37, v226, v14, v37
    v_dot2_f32_bf16 v38, v230, v10, v38
    v_dot2_f32_bf16 v39, v230, v14, v39
    v_dot2_f32_bf16 v40, v234, v10, v40
    v_dot2_f32_bf16 v41, v234, v14, v41
    v_dot2_f32_bf16 v42, v238, v10, v42
    v_dot2_f32_bf16 v43, v238, v14, v43
    v_dot2_f32_bf16 v36, v227, v11, v36
    v_dot2_f32_bf16 v37, v227, v15, v37
    v_dot2_f32_bf16 v38, v231, v11, v38
    v_dot2_f32_bf16 v39, v231, v15, v39
    v_dot2_f32_bf16 v40, v235, v11, v40
    v_dot2_f32_bf16 v41, v235, v15, v41
L_pad7:
    s_cbranch_execz L_walkret
    v_dot2_f32_bf16 v42, v239, v11, v42
    v_dot2_f32_bf16 v43, v239, v15, v43
    v_add_f32_dpp v44, v36, v36 row_ror:8 row_mask:0xf bank_mask:0x3
    v_add_f32_dpp v45, v38, v38 row_ror:8 row_mask:0xf bank_mask:0x3
    v_add_f32_dpp v46, v37, v37 row_ror:8 row_mask:0xf bank_mask:0x3
    v_add_f32_dpp v47, v39, v39 row_ror:8 row_mask:0xf bank_mask:0x3
    v_add_f32_dpp v44, v40, v40 row_ror:8 row_mask:0xf bank_mask:0xc
    v_add_f32_dpp v45, v42, v42 row_ror:8 row_mask:0xf bank_mask:0xc
    v_add_f32_dpp v46, v41, v41 row_ror:8 row_mask:0xf bank_mask:0xc
    v_add_f32_dpp v47, v43, v43 row_ror:8 row_mask:0xf bank_mask:0xc
    v_add_f32_dpp v48, v44, v44 row_half_mirror row_mask:0xf bank_mask:0x5
    v_add_f32_dpp v49, v46, v46 row_half_mirror row_mask:0xf bank_mask:0x5
    s_nop 0
    v_add_f32_dpp v48, v45, v45 row_half_mirror row_mask:0xf bank_mask:0xa
    v_add_f32_dpp v49, v47, v47 row_half_mirror row_mask:0xf bank_mask:0xa
    s_nop 0
    v_add_f32_dpp v48, v48, v48 quad_perm:[1,0,3,2] row_mask:0xf bank_mask:0xf
    v_add_f32_dpp v49, v49, v49 quad_perm:[1,0,3,2] row_mask:0xf bank_mask:0xf
    s_nop 0
    v_add_f32_dpp v48, v48, v48 quad_perm:[2,3,0,1] row_mask:0xf bank_mask:0xf
    v_add_f32_dpp v49, v49, v49 quad_perm:[2,3,0,1] row_mask:0xf bank_mask:0xf
    v_cvt_pk_bf16_f32 v44, v48, v49
    v_lshlrev_b32 v48, 16, v44
    v_and_b32 v49, s69, v44
    v_mul_f32 v48, s71, v48
    v_mul_f32 v49, s71, v49
    v_cvt_pk_bf16_f32 v44, v48, v49
    v_lshlrev_b32 v48, 16, v44
    v_and_b32 v49, s69, v44
    v_mul_f32 v48, s70, v48
    v_mul_f32 v49, s70, v49
    s_nop 0
    v_max_f32_dpp v44, v48, v48 row_ror:4 row_mask:0xf bank_mask:0xf
    v_max_f32_dpp v45, v49, v49 row_ror:4 row_mask:0xf bank_mask:0xf
    s_nop 0
    v_max_f32_dpp v46, v44, v44 row_ror:8 row_mask:0xf bank_mask:0xf
    v_max_f32_dpp v47, v45, v45 row_ror:8 row_mask:0xf bank_mask:0xf
    v_max_f32 v44, v46, v32
    v_max_f32 v45, v47, v33
    v_sub_f32 v50, v32, v44
    v_sub_f32 v51, v33, v45
    v_sub_f32 v48, v48, v44
    v_sub_f32 v49, v49, v45
    v_exp_f32 v48, v48
    v_exp_f32 v49, v49
    v_exp_f32 v50, v50
    v_exp_f32 v51, v51
    v_mov_b32 v32, v44
    v_mov_b32 v33, v45
    v_mov_b32_dpp v36, v48 row_newbcast:0 row_mask:0xf bank_mask:0xf
    v_mov_b32_dpp v37, v49 row_newbcast:0 row_mask:0xf bank_mask:0xf
    v_mov_b32_dpp v38, v48 row_newbcast:4 row_mask:0xf bank_mask:0xf
    v_mov_b32_dpp v39, v49 row_newbcast:4 row_mask:0xf bank_mask:0xf
    v_mov_b32_dpp v40, v48 row_newbcast:8 row_mask:0xf bank_mask:0xf
    v_mov_b32_dpp v41, v49 row_newbcast:8 row_mask:0xf bank_mask:0xf
    v_mov_b32_dpp v42, v48 row_newbcast:12 row_mask:0xf bank_mask:0xf
    v_mov_b32_dpp v43, v49 row_newbcast:12 row_mask:0xf bank_mask:0xf
    v_fma_f32 v34, v34, v50, v48
    v_fma_f32 v35, v35, v51, v49
    v_pk_mul_f32 v[16:17], v[16:17], v[50:51] op_sel:[0,0] op_sel_hi:[1,0]
    v_pk_mul_f32 v[18:19], v[18:19], v[50:51] op_sel:[0,0] op_sel_hi:[1,0]
    v_pk_mul_f32 v[20:21], v[20:21], v[50:51] op_sel:[0,0] op_sel_hi:[1,0]
    v_pk_mul_f32 v[22:23], v[22:23], v[50:51] op_sel:[0,0] op_sel_hi:[1,0]
    v_pk_mul_f32 v[24:25], v[24:25], v[50:51] op_sel:[0,1] op_sel_hi:[1,1]
    v_pk_mul_f32 v[26:27], v[26:27], v[50:51] op_sel:[0,1] op_sel_hi:[1,1]
L_pad8:
    s_cbranch_execz L_walkret
    v_pk_mul_f32 v[28:29], v[28:29], v[50:51] op_sel:[0,1] op_sel_hi:[1,1]
    v_pk_mul_f32 v[30:31], v[30:31], v[50:51] op_sel:[0,1] op_sel_hi:[1,1]
    v_lshlrev_b32 v52, 16, v240
    v_and_b32 v53, s69, v240
    v_lshlrev_b32 v54, 16, v241
    v_and_b32 v55, s69, v241
    v_lshlrev_b32 v56, 16, v242
    v_and_b32 v57, s69, v242
    v_lshlrev_b32 v58, 16, v243
    v_and_b32 v59, s69, v243
    v_pk_fma_f32 v[16:17], v[52:53], v[36:37], v[16:17] op_sel:[0,0,0] op_sel_hi:[1,0,1]
    v_pk_fma_f32 v[24:25], v[52:53], v[36:37], v[24:25] op_sel:[0,1,0] op_sel_hi:[1,1,1]
    v_pk_fma_f32 v[18:19], v[54:55], v[36:37], v[18:19] op_sel:[0,0,0] op_sel_hi:[1,0,1]
    v_pk_fma_f32 v[26:27], v[54:55], v[36:37], v[26:27] op_sel:[0,1,0] op_sel_hi:[1,1,1]
    v_pk_fma_f32 v[20:21], v[56:57], v[36:37], v[20:21] op_sel:[0,0,0] op_sel_hi:[1,0,1]
    v_pk_fma_f32 v[28:29], v[56:57], v[36:37], v[28:29] op_sel:[0,1,0] op_sel_hi:[1,1,1]
    v_pk_fma_f32 v[22:23], v[58:59], v[36:37], v[22:23] op_sel:[0,0,0] op_sel_hi:[1,0,1]
    v_pk_fma_f32 v[30:31], v[58:59], v[36:37], v[30:31] op_sel:[0,1,0] op_sel_hi:[1,1,1]
    v_lshlrev_b32 v52, 16, v244
    v_and_b32 v53, s69, v244
    v_lshlrev_b32 v54, 16, v245
    v_and_b32 v55, s69, v245
    v_lshlrev_b32 v56, 16, v246
    v_and_b32 v57, s69, v246
    v_lshlrev_b32 v58, 16, v247
    v_and_b32 v59, s69, v247
    v_pk_fma_f32 v[16:17], v[52:53], v[38:39], v[16:17] op_sel:[0,0,0] op_sel_hi:[1,0,1]
    v_pk_fma_f32 v[24:25], v[52:53], v[38:39], v[24:25] op_sel:[0,1,0] op_sel_hi:[1,1,1]
    v_pk_fma_f32 v[18:19], v[54:55], v[38:39], v[18:19] op_sel:[0,0,0] op_sel_hi:[1,0,1]
    v_pk_fma_f32 v[26:27], v[54:55], v[38:39], v[26:27] op_sel:[0,1,0] op_sel_hi:[1,1,1]
    v_pk_fma_f32 v[20:21], v[56:57], v[38:39], v[20:21] op_sel:[0,0,0] op_sel_hi:[1,0,1]
    v_pk_fma_f32 v[28:29], v[56:57], v[38:39], v[28:29] op_sel:[0,1,0] op_sel_hi:[1,1,1]
    v_pk_fma_f32 v[22:23], v[58:59], v[38:39], v[22:23] op_sel:[0,0,0] op_sel_hi:[1,0,1]
    v_pk_fma_f32 v[30:31], v[58:59], v[38:39], v[30:31] op_sel:[0,1,0] op_sel_hi:[1,1,1]
    v_lshlrev_b32 v52, 16, v248
    v_and_b32 v53, s69, v248
    v_lshlrev_b32 v54, 16, v249
    v_and_b32 v55, s69, v249
    v_lshlrev_b32 v56, 16, v250
    v_and_b32 v57, s69, v250
    v_lshlrev_b32 v58, 16, v251
    v_and_b32 v59, s69, v251
    v_pk_fma_f32 v[16:17], v[52:53], v[40:41], v[16:17] op_sel:[0,0,0] op_sel_hi:[1,0,1]
    v_pk_fma_f32 v[24:25], v[52:53], v[40:41], v[24:25] op_sel:[0,1,0] op_sel_hi:[1,1,1]
    v_pk_fma_f32 v[18:19], v[54:55], v[40:41], v[18:19] op_sel:[0,0,0] op_sel_hi:[1,0,1]
    v_pk_fma_f32 v[26:27], v[54:55], v[40:41], v[26:27] op_sel:[0,1,0] op_sel_hi:[1,1,1]
    v_pk_fma_f32 v[20:21], v[56:57], v[40:41], v[20:21] op_sel:[0,0,0] op_sel_hi:[1,0,1]
    v_pk_fma_f32 v[28:29], v[56:57], v[40:41], v[28:29] op_sel:[0,1,0] op_sel_hi:[1,1,1]
    v_pk_fma_f32 v[22:23], v[58:59], v[40:41], v[22:23] op_sel:[0,0,0] op_sel_hi:[1,0,1]
    v_pk_fma_f32 v[30:31], v[58:59], v[40:41], v[30:31] op_sel:[0,1,0] op_sel_hi:[1,1,1]
    v_lshlrev_b32 v52, 16, v252
    v_and_b32 v53, s69, v252
    v_lshlrev_b32 v54, 16, v253
    v_and_b32 v55, s69, v253
    v_lshlrev_b32 v56, 16, v254
    v_and_b32 v57, s69, v254
    v_lshlrev_b32 v58, 16, v255
    v_and_b32 v59, s69, v255
    v_pk_fma_f32 v[16:17], v[52:53], v[42:43], v[16:17] op_sel:[0,0,0] op_sel_hi:[1,0,1]
    v_pk_fma_f32 v[24:25], v[52:53], v[42:43], v[24:25] op_sel:[0,1,0] op_sel_hi:[1,1,1]
    v_pk_fma_f32 v[18:19], v[54:55], v[42:43], v[18:19] op_sel:[0,0,0] op_sel_hi:[1,0,1]
    v_pk_fma_f32 v[26:27], v[54:55], v[42:43], v[26:27] op_sel:[0,1,0] op_sel_hi:[1,1,1]
    v_pk_fma_f32 v[20:21], v[56:57], v[42:43], v[20:21] op_sel:[0,0,0] op_sel_hi:[1,0,1]
L_pad9:
    s_cbranch_execz L_walkret
    v_pk_fma_f32 v[28:29], v[56:57], v[42:43], v[28:29] op_sel:[0,1,0] op_sel_hi:[1,1,1]
    v_pk_fma_f32 v[22:23], v[58:59], v[42:43], v[22:23] op_sel:[0,0,0] op_sel_hi:[1,0,1]
    v_pk_fma_f32 v[30:31], v[58:59], v[42:43], v[30:31] op_sel:[0,1,0] op_sel_hi:[1,1,1]
    s_setpc_b64 s[88:89]
L_head2:
L_pad10:
    s_cbranch_execz L_walkret
    s_sub_u32 s76, s64, 5
    s_add_u32 s76, s76, 10
    s_cmp_lt_u32 s64, 5
    s_cselect_b32 s76, 0x7fffffff, s76
    s_mov_b32 s14, 18
    s_mov_b32 s15, 3
    s_call_b64 s[90:91], L_walk
    s_call_b64 s[90:91], L_walk
    s_mul_i32 s79, s64, 1312
    v_add_u32 v44, s79, v43
    s_waitcnt vmcnt(17)
    s_sub_u32 s79, s68, 18
    s_cmp_lt_u32 s79, 36
    s_cbranch_scc1 L_cxok
    s_waitcnt vmcnt(9)
L_cxok:
    s_waitcnt lgkmcnt(0)
    s_mul_i32 s56, s57, 0x9e3779b1
    s_add_u32 s56, s56, 0x7f4a7c15
    s_andn2_b32 s56, s56, 0xff
    s_and_b32 s54, s57, 0xff
    s_cmp_eq_u32 s54, 0xff
    s_cselect_b32 s54, 0, s54
    s_add_u32 s54, s54, 1
    s_or_b32 s56, s56, s54
    s_cmp_ge_u32 s68, 54
    s_cbranch_scc1 L_hln
    v_lshlrev_b32 v168, 16, v48
    v_and_b32 v169, s69, v48
    v_lshlrev_b32 v170, 16, v49
    v_and_b32 v171, s69, v49
    v_lshlrev_b32 v172, 16, v50
    v_and_b32 v173, s69, v50
    v_lshlrev_b32 v174, 16, v51
    v_and_b32 v175, s69, v51
    v_lshlrev_b32 v176, 16, v52
    v_and_b32 v177, s69, v52
    v_mul_f32 v180, s70, v168
    v_mul_f32 v181, s70, v169
    v_mul_f32 v182, s70, v170
    v_mul_f32 v183, s70, v171
    v_mul_f32 v184, s70, v172
    v_mul_f32 v185, s70, v173
    v_mul_f32 v186, s70, v174
    v_mul_f32 v187, s70, v175
    v_mul_f32 v188, s70, v176
    v_mul_f32 v189, s70, v177
    v_exp_f32 v180, -v180
    v_exp_f32 v181, -v181
    v_exp_f32 v182, -v182
    v_exp_f32 v183, -v183
    v_exp_f32 v184, -v184
    v_exp_f32 v185, -v185
    v_exp_f32 v186, -v186
    v_exp_f32 v187, -v187
    v_exp_f32 v188, -v188
    v_exp_f32 v189, -v189
    v_add_f32 v180, 1.0, v180
    v_add_f32 v181, 1.0, v181
    v_add_f32 v182, 1.0, v182
    v_add_f32 v183, 1.0, v183
    v_add_f32 v184, 1.0, v184
    v_add_f32 v185, 1.0, v185
    v_add_f32 v186, 1.0, v186
    v_add_f32 v187, 1.0, v187
    v_add_f32 v188, 1.0, v188
    v_add_f32 v189, 1.0, v189
    v_rcp_f32 v180, v180
    v_rcp_f32 v181, v181
    v_rcp_f32 v182, v182
    v_rcp_f32 v183, v183
    v_rcp_f32 v184, v184
L_pad11:
    s_cbranch_execz L_walkret
    v_rcp_f32 v185, v185
    v_rcp_f32 v186, v186
    v_rcp_f32 v187, v187
    v_rcp_f32 v188, v188
    v_rcp_f32 v189, v189
    v_mul_f32 v168, v168, v180
    v_mul_f32 v169, v169, v181
    v_mul_f32 v170, v170, v182
    v_mul_f32 v171, v171, v183
    v_mul_f32 v172, v172, v184
    v_mul_f32 v173, v173, v185
    v_mul_f32 v174, v174, v186
    v_mul_f32 v175, v175, v187
    v_mul_f32 v176, v176, v188
    v_mul_f32 v177, v177, v189
    v_cvt_pk_bf16_f32 v48, v168, v169
    v_cvt_pk_bf16_f32 v49, v170, v171
    v_cvt_pk_bf16_f32 v50, v172, v173
    v_cvt_pk_bf16_f32 v51, v174, v175
    v_cvt_pk_bf16_f32 v52, v176, v177
    ds_write_b32 v44, v48 offset:0
    ds_write_b32 v44, v49 offset:256
    ds_write_b32 v44, v50 offset:512
    ds_write_b32 v44, v51 offset:768
    ds_write_b32 v44, v52 offset:1024
    s_branch L_hw
L_hln:
    v_readfirstlane_b32 s79, v48
    v_lshlrev_b32 v168, 16, v48
    v_and_b32 v169, s69, v48
    v_lshlrev_b32 v170, 16, v49
    v_and_b32 v171, s69, v49
    v_lshlrev_b32 v172, 16, v50
    v_and_b32 v173, s69, v50
    v_lshlrev_b32 v174, 16, v51
    v_and_b32 v175, s69, v51
    v_lshlrev_b32 v176, 16, v52
    v_and_b32 v177, s69, v52
    s_lshl_b32 s79, s79, 16
    v_mov_b32 v194, s79
    v_mov_b32 v188, 0
    v_mov_b32 v189, 0
    v_pk_add_f32 v[180:181], v[168:169], v[194:195] op_sel:[0,0] op_sel_hi:[1,0] neg_lo:[0,1] neg_hi:[0,1]
    v_pk_add_f32 v[182:183], v[170:171], v[194:195] op_sel:[0,0] op_sel_hi:[1,0] neg_lo:[0,1] neg_hi:[0,1]
    v_pk_add_f32 v[184:185], v[172:173], v[194:195] op_sel:[0,0] op_sel_hi:[1,0] neg_lo:[0,1] neg_hi:[0,1]
    v_pk_add_f32 v[186:187], v[174:175], v[194:195] op_sel:[0,0] op_sel_hi:[1,0] neg_lo:[0,1] neg_hi:[0,1]
    s_mov_b32 exec_hi, 0
    v_pk_add_f32 v[188:189], v[176:177], v[194:195] op_sel:[0,0] op_sel_hi:[1,0] neg_lo:[0,1] neg_hi:[0,1]
    s_mov_b64 exec, -1
    v_pk_add_f32 v[192:193], v[180:181], v[182:183]
    v_pk_mul_f32 v[180:181], v[180:181], v[180:181]
    v_pk_add_f32 v[192:193], v[192:193], v[184:185]
    v_pk_fma_f32 v[180:181], v[182:183], v[182:183], v[180:181]
    v_pk_add_f32 v[192:193], v[192:193], v[186:187]
    v_pk_fma_f32 v[180:181], v[184:185], v[184:185], v[180:181]
    v_pk_add_f32 v[192:193], v[192:193], v[188:189]
    v_pk_fma_f32 v[180:181], v[186:187], v[186:187], v[180:181]
    v_add_f32 v192, v192, v193
    v_pk_fma_f32 v[180:181], v[188:189], v[188:189], v[180:181]
    v_add_f32 v180, v180, v181
    v_add_f32_dpp v192, v192, v192 row_ror:8 row_mask:0xf bank_mask:0xf
    s_nop 0
    v_add_f32_dpp v180, v180, v180 row_ror:8 row_mask:0xf bank_mask:0xf
    v_add_f32_dpp v192, v192, v192 row_ror:4 row_mask:0xf bank_mask:0xf
    s_nop 0
    v_add_f32_dpp v180, v180, v180 row_ror:4 row_mask:0xf bank_mask:0xf
    v_add_f32_dpp v192, v192, v192 row_ror:2 row_mask:0xf bank_mask:0xf
L_pad12:
    s_cbranch_execz L_walkret
    s_nop 0
    v_add_f32_dpp v180, v180, v180 row_ror:2 row_mask:0xf bank_mask:0xf
    v_add_f32_dpp v192, v192, v192 row_ror:1 row_mask:0xf bank_mask:0xf
    s_nop 0
    v_add_f32_dpp v180, v180, v180 row_ror:1 row_mask:0xf bank_mask:0xf
    s_nop 1
    v_permlane32_swap_b32 v192, v180
    v_add_f32 v192, v192, v180
    v_mov_b32 v180, v192
    s_nop 1
    v_permlane16_swap_b32 v192, v180
    v_add_f32 v192, v192, v180
    v_mov_b32 v180, v192
    s_nop 1
    v_permlane32_swap_b32 v192, v180
    v_mul_f32 v192, 0x3ae38e39, v192
    v_mul_f32 v180, 0x3ae38e39, v180
    v_fma_f32 v180, -v192, v192, v180
    v_add_f32 v192, v192, v194
    v_max_f32 v180, 0, v180
    v_cvt_pk_bf16_f32 v194, v192, v180
    v_lshlrev_b32 v192, 16, v194
    v_and_b32 v180, s69, v194
    v_add_f32 v180, 0x3727c5ac, v180
    v_pk_add_f32 v[168:169], v[168:169], v[192:193] op_sel:[0,0] op_sel_hi:[1,0] neg_lo:[0,1] neg_hi:[0,1]
    v_pk_add_f32 v[170:171], v[170:171], v[192:193] op_sel:[0,0] op_sel_hi:[1,0] neg_lo:[0,1] neg_hi:[0,1]
    v_pk_add_f32 v[172:173], v[172:173], v[192:193] op_sel:[0,0] op_sel_hi:[1,0] neg_lo:[0,1] neg_hi:[0,1]
    v_pk_add_f32 v[174:175], v[174:175], v[192:193] op_sel:[0,0] op_sel_hi:[1,0] neg_lo:[0,1] neg_hi:[0,1]
    v_pk_add_f32 v[176:177], v[176:177], v[192:193] op_sel:[0,0] op_sel_hi:[1,0] neg_lo:[0,1] neg_hi:[0,1]
    v_cvt_pk_bf16_f32 v180, v180, v180
    v_lshlrev_b32 v180, 16, v180
    v_sqrt_f32 v180, v180
    v_cvt_pk_bf16_f32 v182, v168, v169
    v_cvt_pk_bf16_f32 v183, v170, v171
    v_cvt_pk_bf16_f32 v184, v172, v173
    v_cvt_pk_bf16_f32 v185, v174, v175
    v_cvt_pk_bf16_f32 v186, v176, v177
    v_cvt_pk_bf16_f32 v180, v180, v180
    v_lshlrev_b32 v180, 16, v180
    v_rcp_f32 v180, v180
    v_lshlrev_b32 v168, 16, v182
    v_and_b32 v169, s69, v182
    v_lshlrev_b32 v170, 16, v183
    v_and_b32 v171, s69, v183
    v_lshlrev_b32 v172, 16, v184
    v_and_b32 v173, s69, v184
    v_lshlrev_b32 v174, 16, v185
    v_and_b32 v175, s69, v185
    v_lshlrev_b32 v176, 16, v186
    v_and_b32 v177, s69, v186
    v_pk_mul_f32 v[168:169], v[168:169], v[180:181] op_sel:[0,0] op_sel_hi:[1,0]
    v_pk_mul_f32 v[170:171], v[170:171], v[180:181] op_sel:[0,0] op_sel_hi:[1,0]
    v_pk_mul_f32 v[172:173], v[172:173], v[180:181] op_sel:[0,0] op_sel_hi:[1,0]
    v_pk_mul_f32 v[174:175], v[174:175], v[180:181] op_sel:[0,0] op_sel_hi:[1,0]
    v_pk_mul_f32 v[176:177], v[176:177], v[180:181] op_sel:[0,0] op_sel_hi:[1,0]
    v_cvt_pk_bf16_f32 v181, v168, v169
    v_cvt_pk_bf16_f32 v182, v170, v171
    v_cvt_pk_bf16_f32 v183, v172, v173
    v_cvt_pk_bf16_f32 v184, v174, v175
    v_cvt_pk_bf16_f32 v185, v176, v177
    v_lshlrev_b32 v168, 16, v181
    v_and_b32 v169, s69, v181
    v_lshlrev_b32 v170, 16, v182
    v_and_b32 v171, s69, v182
    v_lshlrev_b32 v172, 16, v183
L_pad13:
    s_cbranch_execz L_walkret
    v_and_b32 v173, s69, v183
    v_lshlrev_b32 v174, 16, v184
    v_and_b32 v175, s69, v184
    v_lshlrev_b32 v176, 16, v185
    v_and_b32 v177, s69, v185
L_hw:
    s_lshl_b32 s79, s64, 1
    v_bfe_u32 v41, v0, 1, 1
    v_add_u32 v41, s79, v41
    v_bfe_u32 v42, v0, 3, 2
    v_lshlrev_b32 v42, 1, v42
    v_xor_b32 v41, v41, v42
    v_lshrrev_b32 v40, 4, v0
    v_bfe_u32 v42, v0, 2, 2
    v_lshl_add_u32 v40, v40, 3, v42
    v_lshlrev_b32 v40, 7, v40
    v_lshl_add_u32 v40, v41, 4, v40
    v_and_b32 v42, 1, v0
    v_lshl_add_u32 v40, v42, 3, v40
    v_lshrrev_b32 v46, 4, v0
    s_lshl_b32 s79, s64, 5
    v_add_u32 v40, 16384, v40
    v_add_u32 v41, 36864, v40
    s_lshl_b32 s85, s85, 1
    v_and_b32 v42, 7, v0
    v_mul_u32_u24 v47, s85, v42
    v_lshl_add_u32 v47, v46, 4, v47
    v_mul_u32_u24 v42, 1312, v42
    v_lshl_add_u32 v42, v46, 4, v42
    s_add_u32 s83, s84, s79
    s_lshl_b32 s83, s83, 1
    s_cmp_lt_u32 s68, 54
    s_mov_b32 s80, 131072
    s_cselect_b32 s80, 4096, s80
    s_add_u32 s83, s83, s80
    s_waitcnt vmcnt(8) lgkmcnt(0)
    s_sub_u32 s79, s68, 18
    s_cmp_lt_u32 s79, 36
    s_cbranch_scc1 L_wok
    s_waitcnt vmcnt(0)
L_wok:
    s_barrier
    s_cmp_ge_u32 s64, 4
    s_cbranch_scc1 L_hnotr
    ds_read_b64_tr_b16 v[96:97], v40 offset:0
    ds_read_b64_tr_b16 v[98:99], v40 offset:512
    ds_read_b64_tr_b16 v[100:101], v40 offset:4096
    ds_read_b64_tr_b16 v[102:103], v40 offset:4608
    ds_read_b64_tr_b16 v[104:105], v40 offset:8192
    ds_read_b64_tr_b16 v[106:107], v40 offset:8704
    ds_read_b64_tr_b16 v[108:109], v40 offset:12288
    ds_read_b64_tr_b16 v[110:111], v40 offset:12800
    ds_read_b64_tr_b16 v[112:113], v40 offset:16384
    ds_read_b64_tr_b16 v[114:115], v40 offset:16896
    ds_read_b64_tr_b16 v[116:117], v40 offset:20480
    ds_read_b64_tr_b16 v[118:119], v40 offset:20992
    ds_read_b64_tr_b16 v[120:121], v40 offset:24576
    ds_read_b64_tr_b16 v[122:123], v40 offset:25088
    ds_read_b64_tr_b16 v[124:125], v40 offset:28672
    ds_read_b64_tr_b16 v[126:127], v40 offset:29184
    ds_read_b64_tr_b16 v[128:129], v40 offset:32768
    ds_read_b64_tr_b16 v[130:131], v40 offset:33280
    ds_read_b64_tr_b16 v[132:133], v41 offset:0
    ds_read_b64_tr_b16 v[134:135], v41 offset:512
    ds_read_b64_tr_b16 v[136:137], v41 offset:4096
    ds_read_b64_tr_b16 v[138:139], v41 offset:4608
    ds_read_b64_tr_b16 v[140:141], v41 offset:8192
    ds_read_b64_tr_b16 v[142:143], v41 offset:8704
    ds_read_b64_tr_b16 v[144:145], v41 offset:12288
    ds_read_b64_tr_b16 v[146:147], v41 offset:12800
    ds_read_b64_tr_b16 v[148:149], v41 offset:16384
    ds_read_b64_tr_b16 v[150:151], v41 offset:16896
L_pad14:
    s_cbranch_execz L_walkret
    ds_read_b64_tr_b16 v[152:153], v41 offset:20480
    ds_read_b64_tr_b16 v[154:155], v41 offset:20992
    ds_read_b64_tr_b16 v[156:157], v41 offset:24576
    ds_read_b64_tr_b16 v[158:159], v41 offset:25088
    ds_read_b64_tr_b16 v[160:161], v41 offset:28672
    ds_read_b64_tr_b16 v[162:163], v41 offset:29184
    ds_read_b64_tr_b16 v[164:165], v41 offset:32768
    ds_read_b64_tr_b16 v[166:167], v41 offset:33280
L_hnotr:
    s_cmp_lt_u32 s68, 54
    s_cbranch_scc1 L_hbar
    s_add_u32 s30, s28, 6400
    s_addc_u32 s31, s29, 0
    s_mul_i32 s79, s64, 13824
    v_lshlrev_b32 v45, 3, v0
    v_add_u32 v45, s79, v45
    buffer_load_dwordx4 v[64:67], v1, s[32:35], s75 offen offset:0 nt
    buffer_load_dwordx4 v[68:71], v1, s[32:35], s75 offen offset:1024 nt
    buffer_load_dwordx4 v[72:75], v1, s[32:35], s75 offen offset:2048 nt
    buffer_load_dwordx4 v[76:79], v1, s[32:35], s75 offen offset:3072 nt
    buffer_load_dwordx4 v[80:83], v1, s[36:39], s75 offen offset:0 nt
    buffer_load_dwordx4 v[84:87], v1, s[36:39], s75 offen offset:1024 nt
    buffer_load_dwordx4 v[88:91], v1, s[36:39], s75 offen offset:2048 nt
    buffer_load_dwordx4 v[92:95], v1, s[36:39], s75 offen offset:3072 nt
    s_mov_b32 s77, 400000
L_poll_7:
    v_mov_b32 v16, 0
    v_mov_b32 v17, s56
    global_load_dwordx2 v[8:9], v45, s[30:31] offset:-2304 sc1
    global_load_dwordx2 v[10:11], v45, s[30:31] offset:-1792 sc1
    global_load_dwordx2 v[12:13], v45, s[30:31] offset:-1280 sc1
    global_load_dwordx2 v[14:15], v45, s[30:31] offset:-768 sc1
    s_mov_b32 exec_hi, 0
    global_load_dwordx2 v[16:17], v45, s[30:31] offset:-256 sc1
    s_mov_b64 exec, -1
    v_mov_b32 v26, 0
    v_mov_b32 v27, s56
    global_load_dwordx2 v[18:19], v45, s[30:31] offset:0 sc1
    global_load_dwordx2 v[20:21], v45, s[30:31] offset:512 sc1
    global_load_dwordx2 v[22:23], v45, s[30:31] offset:1024 sc1
    global_load_dwordx2 v[24:25], v45, s[30:31] offset:1536 sc1
    s_mov_b32 exec_hi, 0
    global_load_dwordx2 v[26:27], v45, s[30:31] offset:2048 sc1
    s_mov_b64 exec, -1
    s_waitcnt vmcnt(0)
    v_xor_b32 v9, s56, v9
    v_xor_b32 v11, s56, v11
    v_xor_b32 v13, s56, v13
    v_xor_b32 v15, s56, v15
    v_xor_b32 v17, s56, v17
    v_xor_b32 v19, s56, v19
    v_xor_b32 v21, s56, v21
    v_xor_b32 v23, s56, v23
    v_xor_b32 v25, s56, v25
    v_xor_b32 v27, s56, v27
    v_or3_b32 v60, v9, v11, v13
    v_or3_b32 v60, v60, v15, v17
    v_or3_b32 v60, v60, v19, v21
    v_or3_b32 v60, v60, v23, v25
    v_or_b32 v60, v60, v27
    v_cmp_ne_u32 vcc, 0, v60
    s_cbranch_vccz L_pdone_8
    s_sub_u32 s77, s77, 1
    s_cbranch_scc1 L_pdone_8
    s_branch L_poll_7
L_pdone_8:
    v_lshlrev_b32 v180, 16, v18
    v_and_b32 v181, s69, v18
    v_lshlrev_b32 v182, 16, v20
    v_and_b32 v183, s69, v20
    v_lshlrev_b32 v184, 16, v22
    v_and_b32 v185, s69, v22
L_pad15:
    s_cbranch_execz L_walkret
    v_lshlrev_b32 v186, 16, v24
    v_and_b32 v187, s69, v24
    v_lshlrev_b32 v188, 16, v26
    v_and_b32 v189, s69, v26
    v_pk_add_f32 v[180:181], v[180:181], 1.0 op_sel_hi:[1,0]
    v_pk_add_f32 v[182:183], v[182:183], 1.0 op_sel_hi:[1,0]
    v_pk_add_f32 v[184:185], v[184:185], 1.0 op_sel_hi:[1,0]
    v_pk_add_f32 v[186:187], v[186:187], 1.0 op_sel_hi:[1,0]
    v_pk_add_f32 v[188:189], v[188:189], 1.0 op_sel_hi:[1,0]
    v_cvt_pk_bf16_f32 v54, v180, v181
    v_cvt_pk_bf16_f32 v55, v182, v183
    v_cvt_pk_bf16_f32 v56, v184, v185
    v_cvt_pk_bf16_f32 v57, v186, v187
    v_cvt_pk_bf16_f32 v58, v188, v189
    v_lshlrev_b32 v180, 16, v54
    v_and_b32 v181, s69, v54
    v_lshlrev_b32 v182, 16, v55
    v_and_b32 v183, s69, v55
    v_lshlrev_b32 v184, 16, v56
    v_and_b32 v185, s69, v56
    v_lshlrev_b32 v186, 16, v57
    v_and_b32 v187, s69, v57
    v_lshlrev_b32 v188, 16, v58
    v_and_b32 v189, s69, v58
    v_pk_mul_f32 v[168:169], v[168:169], v[180:181]
    v_pk_mul_f32 v[170:171], v[170:171], v[182:183]
    v_pk_mul_f32 v[172:173], v[172:173], v[184:185]
    v_pk_mul_f32 v[174:175], v[174:175], v[186:187]
    v_pk_mul_f32 v[176:177], v[176:177], v[188:189]
    v_cvt_pk_bf16_f32 v54, v168, v169
    v_cvt_pk_bf16_f32 v55, v170, v171
    v_cvt_pk_bf16_f32 v56, v172, v173
    v_cvt_pk_bf16_f32 v57, v174, v175
    v_cvt_pk_bf16_f32 v58, v176, v177
    v_lshlrev_b32 v180, 16, v8
    v_and_b32 v181, s69, v8
    v_lshlrev_b32 v182, 16, v10
    v_and_b32 v183, s69, v10
    v_lshlrev_b32 v184, 16, v12
    v_and_b32 v185, s69, v12
    v_lshlrev_b32 v186, 16, v14
    v_and_b32 v187, s69, v14
    v_lshlrev_b32 v188, 16, v16
    v_and_b32 v189, s69, v16
    v_lshlrev_b32 v168, 16, v54
    v_and_b32 v169, s69, v54
    v_lshlrev_b32 v170, 16, v55
    v_and_b32 v171, s69, v55
    v_lshlrev_b32 v172, 16, v56
    v_and_b32 v173, s69, v56
    v_lshlrev_b32 v174, 16, v57
    v_and_b32 v175, s69, v57
    v_lshlrev_b32 v176, 16, v58
    v_and_b32 v177, s69, v58
    v_pk_add_f32 v[168:169], v[168:169], v[180:181]
    v_pk_add_f32 v[170:171], v[170:171], v[182:183]
    v_pk_add_f32 v[172:173], v[172:173], v[184:185]
    v_pk_add_f32 v[174:175], v[174:175], v[186:187]
    v_pk_add_f32 v[176:177], v[176:177], v[188:189]
    v_cvt_pk_bf16_f32 v48, v168, v169
    v_cvt_pk_bf16_f32 v49, v170, v171
    v_cvt_pk_bf16_f32 v50, v172, v173
    v_cvt_pk_bf16_f32 v51, v174, v175
L_pad16:
    s_cbranch_execz L_walkret
    v_cvt_pk_bf16_f32 v52, v176, v177
    ds_write_b32 v44, v48 offset:0
    ds_write_b32 v44, v49 offset:256
    ds_write_b32 v44, v50 offset:512
    ds_write_b32 v44, v51 offset:768
    ds_write_b32 v44, v52 offset:1024
L_hbar:
    s_waitcnt lgkmcnt(0)
    s_barrier
    s_cmp_eq_u32 s64, 7
    s_cbranch_scc1 L_qsvc
    s_cmp_ge_u32 s64, 4
    s_cbranch_scc1 L_streamh
    ds_read_b128 v[168:171], v42 offset:0
    ds_read_b128 v[172:175], v42 offset:64
    ds_read_b128 v[176:179], v42 offset:128
    ds_read_b128 v[180:183], v42 offset:192
    ds_read_b128 v[184:187], v42 offset:256
    ds_read_b128 v[188:191], v42 offset:320
    ds_read_b128 v[192:195], v42 offset:384
    ds_read_b128 v[196:199], v42 offset:448
    ds_read_b128 v[200:203], v42 offset:512
    ds_read_b128 v[204:207], v42 offset:576
    ds_read_b128 v[208:211], v42 offset:640
    ds_read_b128 v[212:215], v42 offset:704
    ds_read_b128 v[216:219], v42 offset:768
    ds_read_b128 v[220:223], v42 offset:832
    ds_read_b128 v[224:227], v42 offset:896
    ds_read_b128 v[228:231], v42 offset:960
    ds_read_b128 v[232:235], v42 offset:1024
    ds_read_b128 v[236:239], v42 offset:1088
    s_waitcnt lgkmcnt(15)
    v_mfma_f32_16x16x32_bf16 v[36:39], v[96:99], v[168:171], 0
    s_waitcnt lgkmcnt(15)
    v_mfma_f32_16x16x32_bf16 v[36:39], v[100:103], v[172:175], v[36:39]
    s_waitcnt lgkmcnt(15)
    v_mfma_f32_16x16x32_bf16 v[36:39], v[104:107], v[176:179], v[36:39]
    s_waitcnt lgkmcnt(14)
    v_mfma_f32_16x16x32_bf16 v[36:39], v[108:111], v[180:183], v[36:39]
    s_waitcnt lgkmcnt(13)
    v_mfma_f32_16x16x32_bf16 v[36:39], v[112:115], v[184:187], v[36:39]
    s_waitcnt lgkmcnt(12)
    v_mfma_f32_16x16x32_bf16 v[36:39], v[116:119], v[188:191], v[36:39]
    s_waitcnt lgkmcnt(11)
    v_mfma_f32_16x16x32_bf16 v[36:39], v[120:123], v[192:195], v[36:39]
    s_waitcnt lgkmcnt(10)
    v_mfma_f32_16x16x32_bf16 v[36:39], v[124:127], v[196:199], v[36:39]
    s_waitcnt lgkmcnt(9)
    v_mfma_f32_16x16x32_bf16 v[36:39], v[128:131], v[200:203], v[36:39]
    s_waitcnt lgkmcnt(8)
    v_mfma_f32_16x16x32_bf16 v[36:39], v[132:135], v[204:207], v[36:39]
    s_waitcnt lgkmcnt(7)
    v_mfma_f32_16x16x32_bf16 v[36:39], v[136:139], v[208:211], v[36:39]
    s_waitcnt lgkmcnt(6)
    v_mfma_f32_16x16x32_bf16 v[36:39], v[140:143], v[212:215], v[36:39]
    s_waitcnt lgkmcnt(5)
    v_mfma_f32_16x16x32_bf16 v[36:39], v[144:147], v[216:219], v[36:39]
    s_waitcnt lgkmcnt(4)
    v_mfma_f32_16x16x32_bf16 v[36:39], v[148:151], v[220:223], v[36:39]
    s_waitcnt lgkmcnt(3)
    v_mfma_f32_16x16x32_bf16 v[36:39], v[152:155], v[224:227], v[36:39]
    s_waitcnt lgkmcnt(2)
    v_mfma_f32_16x16x32_bf16 v[36:39], v[156:159], v[228:231], v[36:39]
    s_waitcnt lgkmcnt(1)
    v_mfma_f32_16x16x32_bf16 v[36:39], v[160:163], v[232:235], v[36:39]
    s_waitcnt lgkmcnt(0)
    v_mfma_f32_16x16x32_bf16 v[36:39], v[164:167], v[236:239], v[36:39]
    v_mov_b32 v9, s56
    v_mov_b32 v11, s56
    s_nop 5
    v_cvt_pk_bf16_f32 v8, v36, v37
    v_cvt_pk_bf16_f32 v10, v38, v39
    s_mov_b32 exec_lo, 0xff00ff
    s_mov_b32 exec_hi, 0xff00ff
    buffer_store_dwordx4 v[8:11], v47, s[60:63], s83 offen sc1
    s_mov_b64 exec, -1
L_streamh:
    s_cmp_ge_u32 s2, 156
L_pad17:
    s_cbranch_execz L_walkret
    s_cbranch_scc1 L_stream1
    s_branch L_stream
L_qsvc:
    s_mov_b32 s76, 0
    s_mov_b32 s14, 10
    s_mov_b32 s15, 1
    s_waitcnt lgkmcnt(0)
    s_mul_i32 s56, s57, 0x9e3779b1
    s_add_u32 s56, s56, 0x7f4a7c15
    s_andn2_b32 s56, s56, 0xff
    s_and_b32 s54, s57, 0xff
    s_cmp_eq_u32 s54, 0xff
    s_cselect_b32 s54, 0, s54
    s_add_u32 s54, s54, 1
    s_or_b32 s56, s56, s54
    s_cmp_lg_u32 s67, 0
    s_cbranch_scc1 L_qs1
    s_lshl_b32 s79, s65, 4
    s_add_u32 s79, s79, s66
    s_lshl_b32 s79, s79, 7
    s_add_u32 s79, s79, 262144
    v_mov_b32 v45, s79
    v_mov_b32 v8, 0
    v_mov_b32 v9, s56
    s_mov_b64 exec, 1
    global_store_dwordx2 v45, v[8:9], s[28:29] sc1
    s_mov_b64 exec, -1
L_qs1:
    s_lshl_b32 s79, s65, 14
    s_lshl_b32 s80, s66, 10
    s_add_u32 s79, s79, s80
    s_add_u32 s79, s79, 131072
    v_lshlrev_b32 v45, 3, v0
L_qwalk:
    s_call_b64 s[90:91], L_walk
    s_cmp_lt_u32 s76, s14
    s_cbranch_scc1 L_qwalk
    s_mov_b32 s77, 400000
L_poll_9:
    buffer_load_dwordx4 v[8:11], v1, s[60:63], s79 offen sc1
    s_waitcnt vmcnt(0)
    v_xor_b32 v9, s56, v9
    v_xor_b32 v11, s56, v11
    v_or_b32 v48, v9, v11
    v_cmp_ne_u32 vcc, 0, v48
    s_cbranch_vccz L_pdone_10
    s_sub_u32 s77, s77, 1
    s_cbranch_scc1 L_pdone_10
    s_sleep 2
    s_branch L_poll_9
L_pdone_10:
    v_mov_b32 v9, v10
    ds_write_b64 v45, v[8:9] offset:14848
    s_waitcnt lgkmcnt(0)
    ds_write_b32 v4, v6 offset:4
    s_branch L_streamh
L_tail:
L_pad18:
    s_cbranch_execz L_walkret
    v_lshlrev_b32 v62, 3, v0
    v_mov_b32 v52, 0xff
    v_mov_b32 v53, s54
    v_mov_b32 v44, v32
    v_mov_b32 v45, v33
    v_mov_b32 v46, v32
    v_mov_b32 v47, v33
    v_add_f32_dpp v34, v34, v34 row_ror:4 row_mask:0xf bank_mask:0xf
    v_add_f32_dpp v35, v35, v35 row_ror:4 row_mask:0xf bank_mask:0xf
    v_permlane16_swap_b32 v44, v46
    v_permlane16_swap_b32 v45, v47
    v_max_f32 v44, v44, v46
    v_max_f32 v45, v45, v47
    v_mov_b32 v46, v44
    v_mov_b32 v47, v45
    v_add_f32_dpp v34, v34, v34 row_ror:8 row_mask:0xf bank_mask:0xf
    v_add_f32_dpp v35, v35, v35 row_ror:8 row_mask:0xf bank_mask:0xf
    v_permlane32_swap_b32 v44, v46
    v_permlane32_swap_b32 v45, v47
    v_max_f32 v44, v44, v46
    v_max_f32 v45, v45, v47
    v_sub_f32 v50, v32, v44
    v_sub_f32 v51, v33, v45
    v_exp_f32 v50, v50
    v_exp_f32 v51, v51
    v_permlane32_swap_b32 v44, v45
    v_mul_f32 v34, v34, v50
    v_mul_f32 v35, v35, v51
    v_pk_mul_f32 v[16:17], v[16:17], v[50:51] op_sel:[0,0] op_sel_hi:[1,0]
    v_pk_mul_f32 v[18:19], v[18:19], v[50:51] op_sel:[0,0] op_sel_hi:[1,0]
    v_pk_mul_f32 v[20:21], v[20:21], v[50:51] op_sel:[0,0] op_sel_hi:[1,0]
    v_pk_mul_f32 v[22:23], v[22:23], v[50:51] op_sel:[0,0] op_sel_hi:[1,0]
    v_pk_mul_f32 v[24:25], v[24:25], v[50:51] op_sel:[0,1] op_sel_hi:[1,1]
    v_pk_mul_f32 v[26:27], v[26:27], v[50:51] op_sel:[0,1] op_sel_hi:[1,1]
    v_pk_mul_f32 v[28:29], v[28:29], v[50:51] op_sel:[0,1] op_sel_hi:[1,1]
    v_pk_mul_f32 v[30:31], v[30:31], v[50:51] op_sel:[0,1] op_sel_hi:[1,1]
    v_permlane32_swap_b32 v34, v35
    v_permlane32_swap_b32 v16, v24
    v_permlane32_swap_b32 v17, v25
    v_permlane32_swap_b32 v18, v26
    v_permlane32_swap_b32 v19, v27
    v_permlane32_swap_b32 v20, v28
    v_permlane32_swap_b32 v21, v29
    v_permlane32_swap_b32 v22, v30
    v_permlane32_swap_b32 v23, v31
    v_add_f32 v45, v34, v35
    v_add_f32 v16, v16, v24
    v_add_f32 v17, v17, v25
    v_add_f32 v18, v18, v26
    v_add_f32 v19, v19, v27
    v_add_f32 v20, v20, v28
    v_add_f32 v21, v21, v29
    v_add_f32 v22, v22, v30
    v_add_f32 v23, v23, v31
    v_mov_b32 v46, v45
    v_permlane16_swap_b32 v16, v20
    v_permlane16_swap_b32 v17, v21
    v_permlane16_swap_b32 v18, v22
    v_permlane16_swap_b32 v19, v23
    v_permlane16_swap_b32 v45, v46
    v_add_f32 v16, v16, v20
    v_add_f32 v17, v17, v21
    v_add_f32 v18, v18, v22
L_pad19:
    s_cbranch_execz L_walkret
    v_add_f32 v19, v19, v23
    v_add_f32 v45, v45, v46
    ds_write_b128 v117, v[16:19] offset:0
    s_mov_b32 exec_lo, 1
    s_mov_b32 exec_hi, 1
    ds_write_b64 v118, v[44:45] offset:8192
    s_mov_b64 exec, -1
    s_lshl_b32 s80, s64, 6
    v_mov_b32 v61, s80
    s_lshl_b32 s79, s64, 9
    v_lshl_add_u32 v60, v0, 3, s79
    s_cmp_ge_u32 s78, 144
    s_cbranch_scc1 L_nowl
    s_lshl_b32 s81, s64, 12
    s_add_u32 m0, s81, 16384
    s_nop 0
    buffer_load_dwordx4 v120, s[40:43], s84 offen nt lds
    s_add_u32 m0, m0, 1024
    s_add_u32 s84, s84, 9216
    buffer_load_dwordx4 v121, s[40:43], s84 offen nt lds
    s_add_u32 m0, m0, 1024
    s_add_u32 s84, s84, 9216
    buffer_load_dwordx4 v120, s[40:43], s84 offen nt lds
    s_add_u32 m0, m0, 1024
    s_add_u32 s84, s84, 9216
    buffer_load_dwordx4 v121, s[40:43], s84 offen nt lds
L_nowl:
    s_waitcnt lgkmcnt(0)
    s_barrier
    s_cmp_ge_u32 s64, 2
    s_cbranch_scc1 L_t2
    ds_read_b128 v[8:11], v61 offset:8192
    ds_read_b128 v[12:15], v61 offset:8208
    ds_read_b128 v[16:19], v61 offset:8224
    ds_read_b128 v[20:23], v61 offset:8240
    ds_read_b64 v[24:25], v60 offset:0
    ds_read_b64 v[26:27], v60 offset:1024
    ds_read_b64 v[28:29], v60 offset:2048
    ds_read_b64 v[30:31], v60 offset:3072
    ds_read_b64 v[32:33], v60 offset:4096
    ds_read_b64 v[34:35], v60 offset:5120
    ds_read_b64 v[36:37], v60 offset:6144
    ds_read_b64 v[38:39], v60 offset:7168
    s_lshl_b32 s79, s65, 4
    s_add_u32 s79, s79, s66
    s_lshl_b32 s79, s79, 1
    s_add_u32 s79, s79, s67
    s_mul_i32 s79, s79, 1152
    s_add_u32 s79, s79, 1048576
    s_lshl_b32 s80, s64, 9
    s_add_u32 s80, s80, s79
    s_lshl_b32 s81, s64, 4
    s_add_u32 s81, s81, s79
    v_mov_b32 v49, s56
    v_mov_b32 v51, s56
    s_waitcnt lgkmcnt(8)
    v_max3_f32 v40, v8, v10, v12
    v_max3_f32 v41, v14, v16, v18
    v_max3_f32 v40, v40, v20, v22
    v_max_f32 v40, v40, v41
    v_sub_f32 v8, v8, v40
    v_sub_f32 v10, v10, v40
    v_sub_f32 v12, v12, v40
    v_sub_f32 v14, v14, v40
    v_sub_f32 v16, v16, v40
    v_sub_f32 v18, v18, v40
    v_sub_f32 v20, v20, v40
    v_sub_f32 v22, v22, v40
    v_exp_f32 v8, v8
    v_exp_f32 v10, v10
    v_exp_f32 v12, v12
    v_exp_f32 v14, v14
    v_exp_f32 v16, v16
    v_exp_f32 v18, v18
L_pad20:
    s_cbranch_execz L_walkret
    v_exp_f32 v20, v20
    v_exp_f32 v22, v22
    v_mul_f32 v41, v8, v9
    v_mul_f32 v44, v10, v11
    v_fmac_f32 v41, v12, v13
    v_fmac_f32 v44, v14, v15
    v_fmac_f32 v41, v16, v17
    v_fmac_f32 v44, v18, v19
    v_fmac_f32 v41, v20, v21
    v_fmac_f32 v44, v22, v23
    v_add_f32 v41, v41, v44
    s_waitcnt lgkmcnt(0)
    v_rcp_f32 v44, v41
    v_pk_mul_f32 v[42:43], v[24:25], v[8:9] op_sel:[0,0] op_sel_hi:[1,0]
    v_pk_mul_f32 v[46:47], v[26:27], v[10:11] op_sel:[0,0] op_sel_hi:[1,0]
    v_pk_fma_f32 v[42:43], v[28:29], v[12:13], v[42:43] op_sel:[0,0,0] op_sel_hi:[1,0,1]
    v_pk_fma_f32 v[46:47], v[30:31], v[14:15], v[46:47] op_sel:[0,0,0] op_sel_hi:[1,0,1]
    v_pk_fma_f32 v[42:43], v[32:33], v[16:17], v[42:43] op_sel:[0,0,0] op_sel_hi:[1,0,1]
    v_pk_fma_f32 v[46:47], v[34:35], v[18:19], v[46:47] op_sel:[0,0,0] op_sel_hi:[1,0,1]
    v_pk_fma_f32 v[42:43], v[36:37], v[20:21], v[42:43] op_sel:[0,0,0] op_sel_hi:[1,0,1]
    v_pk_fma_f32 v[46:47], v[38:39], v[22:23], v[46:47] op_sel:[0,0,0] op_sel_hi:[1,0,1]
    v_pk_add_f32 v[42:43], v[42:43], v[46:47]
    v_mul_f32 v42, v42, v44
    v_mul_f32 v43, v43, v44
    v_mov_b32 v48, v40
    v_mov_b32 v50, v41
    v_bfi_b32 v42, v52, v53, v42
    buffer_store_dwordx2 v[42:43], v62, s[60:63], s80 offen sc1
    s_mov_b64 exec, 1
    buffer_store_dwordx4 v[48:51], v62, s[60:63], s81 offen offset:1024 sc1
    s_mov_b64 exec, -1
L_t2:
    s_cmp_lt_u32 s53, 72
    s_cbranch_scc1 L_ffn
    s_cmp_ge_u32 s78, 144
    s_cbranch_scc1 L_fin
    s_mul_i32 s66, s78, 7282
    s_lshr_b32 s66, s66, 16
    s_mul_i32 s80, s66, 9
    s_sub_u32 s84, s78, s80
    s_lshr_b32 s79, s64, 2
    s_and_b32 s80, s64, 3
    s_lshl_b32 s82, s80, 1
    v_bfe_u32 v56, v0, 1, 1
    v_add_u32 v56, s82, v56
    v_bfe_u32 v59, v0, 3, 2
    v_lshlrev_b32 v59, 1, v59
    v_xor_b32 v56, v56, v59
    v_lshrrev_b32 v58, 4, v0
    v_bfe_u32 v59, v0, 2, 2
    v_lshl_add_u32 v58, v58, 3, v59
    v_lshlrev_b32 v58, 7, v58
    v_lshl_add_u32 v58, v56, 4, v58
    v_and_b32 v59, 1, v0
    v_lshl_add_u32 v58, v59, 3, v58
    v_lshrrev_b32 v57, 4, v0
    s_lshl_b32 s81, s79, 14
    s_add_u32 s81, s81, 16384
    v_add_u32 v58, s81, v58
    v_lshlrev_b32 v60, 3, v0
    v_lshrrev_b32 v61, 5, v0
    v_lshlrev_b32 v61, 4, v61
    s_lshl_b32 s81, s64, 4
    s_add_u32 s81, s81, s66
    s_mul_i32 s81, s81, 2304
    s_add_u32 s81, s81, 1048576
    s_mul_i32 s82, s64, 544
    s_add_u32 s82, s82, 49152
    v_add_u32 v56, s82, v60
    v_and_b32 v59, 7, v0
    v_mul_u32_u24 v55, 544, v59
L_pad21:
    s_cbranch_execz L_walkret
    v_lshl_add_u32 v55, v57, 4, v55
    s_lshl_b32 s82, s79, 8
    s_add_u32 s82, s82, 49152
    v_add_u32 v55, s82, v55
    v_mul_u32_u24 v54, 2304, v59
    v_lshl_add_u32 v54, v57, 4, v54
    s_lshl_b32 s83, s66, 1
    s_add_u32 s83, s83, s79
    s_mul_i32 s83, s83, 18432
    s_lshl_b32 s82, s84, 8
    s_add_u32 s83, s83, s82
    s_lshl_b32 s82, s80, 6
    s_add_u32 s83, s83, s82
    s_add_u32 s83, s83, 1343488
    s_cmp_lg_u32 s64, 7
    s_cbranch_scc1 L_noprep
    s_mul_i32 s65, s78, 3641
    s_lshr_b32 s65, s65, 16
    s_mul_i32 s80, s65, 18
    s_sub_u32 s78, s78, s80
    v_and_b32 v48, 7, v0
    v_lshrrev_b32 v50, 3, v0
    v_mul_u32_u24 v50, 18432, v50
    v_lshl_add_u32 v50, v48, 4, v50
    v_bfe_u32 v51, v0, 4, 1
    v_lshlrev_b32 v51, 1, v51
    v_lshrrev_b32 v47, 5, v0
    v_add_u32 v51, v51, v47
    v_lshl_add_u32 v51, v48, 2, v51
    v_lshlrev_b32 v51, 1, v51
    v_lshrrev_b32 v47, 2, v51
    v_lshlrev_b32 v46, 2, v47
    v_lshlrev_b32 v47, 3, v47
    s_mul_i32 s41, s65, 2304
    s_lshl_b32 s80, s78, 7
    s_add_u32 s41, s41, s80
    s_add_u32 s40, s41, 1343488
    s_add_u32 s41, s41, 1966080
    s_mul_i32 s43, s65, 13824
    s_add_u32 s43, s43, s80
    s_add_u32 s43, s43, 8704
    s_add_u32 s85, s43, 6912
    s_mul_i32 s42, s65, 1152
    s_lshl_b32 s80, s78, 6
    s_add_u32 s42, s42, s80
    v_add_u32 v51, s42, v51
    global_load_ushort v44, v51, s[4:5]
    s_lshl_b32 s42, s42, 1
    s_add_u32 s42, s42, 1933312
    s_mov_b32 s77, 400000
L_poll_11:
    buffer_load_dwordx2 v[92:93], v47, s[60:63], s43 offen sc1
    buffer_load_dwordx2 v[94:95], v47, s[60:63], s85 offen sc1
    s_waitcnt vmcnt(0)
    v_xor_b32 v93, s56, v93
    v_xor_b32 v95, s56, v95
    v_or_b32 v57, v93, v95
    v_cmp_ne_u32 vcc, 0, v57
    s_cbranch_vccz L_pdone_12
    s_sub_u32 s77, s77, 1
    s_cbranch_scc1 L_pdone_12
    s_sleep 1
    s_branch L_poll_11
L_pdone_12:
    v_lshlrev_b32 v40, 16, v92
    v_lshlrev_b32 v41, 16, v94
    s_mov_b32 exec_lo, 0
    v_and_b32 v40, s69, v92
    v_and_b32 v41, s69, v94
    s_mov_b64 exec, -1
    v_lshlrev_b32 v44, 16, v44
L_noprep:
    s_mov_b32 s77, 400000
L_poll_13:
    buffer_load_dwordx4 v[12:15], v61, s[60:63], s81 offen offset:1024 sc1
    buffer_load_dwordx4 v[16:19], v61, s[60:63], s81 offen offset:2176 sc1
    buffer_load_dwordx4 v[20:23], v1, s[60:63], s81 offen sc1
    buffer_load_dwordx4 v[24:27], v1, s[60:63], s81 offen offset:1152 sc1
    s_waitcnt vmcnt(0)
    v_xor_b32 v13, s56, v13
L_pad22:
    s_cbranch_execz L_walkret
    v_xor_b32 v15, s56, v15
    v_xor_b32 v17, s56, v17
    v_xor_b32 v19, s56, v19
    v_or3_b32 v8, v13, v15, v17
    v_or_b32 v8, v8, v19
    v_msad_u8 v9, v20, v53, 0
    v_msad_u8 v9, v22, v53, v9
    v_msad_u8 v9, v24, v53, v9
    v_msad_u8 v9, v26, v53, v9
    v_or_b32 v8, v8, v9
    v_cmp_ne_u32 vcc, 0, v8
    s_cbranch_vccz L_pdone_14
    s_sub_u32 s77, s77, 1
    s_cbranch_scc1 L_pdone_14
    s_branch L_poll_13
L_pdone_14:
    v_max_f32 v8, v12, v16
    v_sub_f32 v12, v12, v8
    v_sub_f32 v16, v16, v8
    v_exp_f32 v12, v12
    v_exp_f32 v16, v16
    v_mul_f32 v12, v12, v14
    v_mul_f32 v13, v16, v18
    v_add_f32 v16, v12, v13
    v_rcp_f32 v16, v16
    s_nop 0
    v_mul_f32 v12, v12, v16
    v_mul_f32 v13, v13, v16
    v_pk_mul_f32 v[20:21], v[20:21], v[12:13] op_sel:[0,0] op_sel_hi:[1,0]
    v_pk_mul_f32 v[22:23], v[22:23], v[12:13] op_sel:[0,0] op_sel_hi:[1,0]
    v_pk_fma_f32 v[20:21], v[24:25], v[12:13], v[20:21] op_sel:[0,1,0] op_sel_hi:[1,1,1]
    v_pk_fma_f32 v[22:23], v[26:27], v[12:13], v[22:23] op_sel:[0,1,0] op_sel_hi:[1,1,1]
    v_cvt_pk_bf16_f32 v8, v20, v21
    v_cvt_pk_bf16_f32 v9, v22, v23
    ds_write_b64 v56, v[8:9]
    s_waitcnt lgkmcnt(0)
    s_barrier
    ds_read_b64_tr_b16 v[96:97], v58 offset:0
    ds_read_b64_tr_b16 v[98:99], v58 offset:512
    ds_read_b128 v[8:11], v55 offset:0
    ds_read_b64_tr_b16 v[100:101], v58 offset:4096
    ds_read_b64_tr_b16 v[102:103], v58 offset:4608
    ds_read_b128 v[12:15], v55 offset:64
    ds_read_b64_tr_b16 v[104:105], v58 offset:8192
    ds_read_b64_tr_b16 v[106:107], v58 offset:8704
    ds_read_b128 v[16:19], v55 offset:128
    ds_read_b64_tr_b16 v[108:109], v58 offset:12288
    ds_read_b64_tr_b16 v[110:111], v58 offset:12800
    ds_read_b128 v[20:23], v55 offset:192
    s_waitcnt lgkmcnt(9)
    v_mfma_f32_16x16x32_bf16 v[24:27], v[96:99], v[8:11], 0
    s_waitcnt lgkmcnt(6)
    v_mfma_f32_16x16x32_bf16 v[24:27], v[100:103], v[12:15], v[24:27]
    s_waitcnt lgkmcnt(3)
    v_mfma_f32_16x16x32_bf16 v[24:27], v[104:107], v[16:19], v[24:27]
    s_waitcnt lgkmcnt(0)
    v_mfma_f32_16x16x32_bf16 v[24:27], v[108:111], v[20:23], v[24:27]
    s_mov_b32 exec_lo, 0xff00ff
    s_mov_b32 exec_hi, 0xff00ff
    s_nop 5
    v_bfi_b32 v24, v52, v53, v24
    v_bfi_b32 v26, v52, v53, v26
    buffer_store_dwordx4 v[24:27], v54, s[60:63], s83 offen sc1
    s_mov_b64 exec, -1
    s_cmp_lg_u32 s64, 7
    s_cbranch_scc1 L_fin
    s_mov_b32 s77, 400000
L_poll_15:
    s_mov_b32 s79, s40
    buffer_load_dwordx4 v[96:99], v50, s[60:63], s79 offen sc1
    s_add_u32 s79, s79, 147456
    buffer_load_dwordx4 v[100:103], v50, s[60:63], s79 offen sc1
    s_add_u32 s79, s79, 147456
L_pad23:
    s_cbranch_execz L_walkret
    buffer_load_dwordx4 v[104:107], v50, s[60:63], s79 offen sc1
    s_add_u32 s79, s79, 147456
    buffer_load_dwordx4 v[108:111], v50, s[60:63], s79 offen sc1
    s_waitcnt vmcnt(3)
    v_msad_u8 v45, v96, v53, 0
    v_msad_u8 v45, v98, v53, v45
    s_waitcnt vmcnt(2)
    v_msad_u8 v45, v100, v53, v45
    v_msad_u8 v45, v102, v53, v45
    v_pk_add_f32 v[96:97], v[96:97], v[100:101]
    v_pk_add_f32 v[98:99], v[98:99], v[102:103]
    s_waitcnt vmcnt(1)
    v_msad_u8 v45, v104, v53, v45
    v_msad_u8 v45, v106, v53, v45
    v_pk_add_f32 v[96:97], v[96:97], v[104:105]
    v_pk_add_f32 v[98:99], v[98:99], v[106:107]
    s_waitcnt vmcnt(0)
    v_msad_u8 v45, v108, v53, v45
    v_msad_u8 v45, v110, v53, v45
    v_pk_add_f32 v[96:97], v[96:97], v[108:109]
    v_pk_add_f32 v[98:99], v[98:99], v[110:111]
    v_cmp_ne_u32 vcc, 0, v45
    s_cbranch_vccz L_pdone_16
    s_sub_u32 s77, s77, 1
    s_cbranch_scc0 L_poll_15
L_pdone_16:
    v_add_f32_dpp v96, v96, v96 row_ror:8 row_mask:0xf bank_mask:0xf
    v_add_f32_dpp v97, v97, v97 row_ror:8 row_mask:0xf bank_mask:0xf
    v_add_f32_dpp v98, v98, v98 row_ror:8 row_mask:0xf bank_mask:0xf
    v_add_f32_dpp v99, v99, v99 row_ror:8 row_mask:0xf bank_mask:0xf
    v_permlane32_swap_b32 v96, v97
    s_nop 0
    v_permlane32_swap_b32 v98, v99
    v_add_f32 v96, v96, v97
    v_add_f32 v98, v98, v99
    s_nop 1
    v_permlane16_swap_b32 v96, v98
    v_add_f32 v96, v96, v98
    v_cvt_pk_bf16_f32 v96, v96, v96
    v_lshlrev_b32 v96, 16, v96
    v_mul_f32 v96, v96, v40
    v_cvt_pk_bf16_f32 v96, v96, v96
    v_lshlrev_b32 v96, 16, v96
    v_add_f32 v96, v96, v44
    v_cvt_pk_bf16_f32 v96, v96, v96
    v_and_b32 v44, s69, v96
    v_mov_b32 v97, v96
    s_nop 1
    v_permlane32_swap_b32 v96, v97
    v_bfi_b32 v96, s69, v97, v96
    v_mov_b32 v97, s56
    s_mov_b32 exec_lo, 0xff00ff
    s_mov_b32 exec_hi, 0
    buffer_store_dwordx2 v[96:97], v47, s[60:63], s42 offen sc1
    s_mov_b64 exec, -1
    s_mov_b32 s77, 400000
L_poll_17:
    s_mov_b32 s79, s41
    buffer_load_dwordx4 v[96:99], v50, s[60:63], s79 offen sc1
    s_add_u32 s79, s79, 147456
    buffer_load_dwordx4 v[100:103], v50, s[60:63], s79 offen sc1
    s_add_u32 s79, s79, 147456
    buffer_load_dwordx4 v[104:107], v50, s[60:63], s79 offen sc1
    s_add_u32 s79, s79, 147456
    buffer_load_dwordx4 v[108:111], v50, s[60:63], s79 offen sc1
    s_add_u32 s79, s79, 147456
    buffer_load_dwordx4 v[112:115], v50, s[60:63], s79 offen sc1
    s_add_u32 s79, s79, 147456
    buffer_load_dwordx4 v[116:119], v50, s[60:63], s79 offen sc1
    s_add_u32 s79, s79, 147456
    buffer_load_dwordx4 v[120:123], v50, s[60:63], s79 offen sc1
L_pad24:
    s_cbranch_execz L_walkret
    s_add_u32 s79, s79, 147456
    buffer_load_dwordx4 v[124:127], v50, s[60:63], s79 offen sc1
    s_add_u32 s79, s79, 147456
    buffer_load_dwordx4 v[128:131], v50, s[60:63], s79 offen sc1
    s_waitcnt vmcnt(8)
    v_msad_u8 v45, v96, v53, 0
    v_msad_u8 v45, v98, v53, v45
    s_waitcnt vmcnt(7)
    v_msad_u8 v45, v100, v53, v45
    v_msad_u8 v45, v102, v53, v45
    v_pk_add_f32 v[96:97], v[96:97], v[100:101]
    v_pk_add_f32 v[98:99], v[98:99], v[102:103]
    s_waitcnt vmcnt(6)
    v_msad_u8 v45, v104, v53, v45
    v_msad_u8 v45, v106, v53, v45
    v_pk_add_f32 v[96:97], v[96:97], v[104:105]
    v_pk_add_f32 v[98:99], v[98:99], v[106:107]
    s_waitcnt vmcnt(5)
    v_msad_u8 v45, v108, v53, v45
    v_msad_u8 v45, v110, v53, v45
    v_pk_add_f32 v[96:97], v[96:97], v[108:109]
    v_pk_add_f32 v[98:99], v[98:99], v[110:111]
    s_waitcnt vmcnt(4)
    v_msad_u8 v45, v112, v53, v45
    v_msad_u8 v45, v114, v53, v45
    v_pk_add_f32 v[96:97], v[96:97], v[112:113]
    v_pk_add_f32 v[98:99], v[98:99], v[114:115]
    s_waitcnt vmcnt(3)
    v_msad_u8 v45, v116, v53, v45
    v_msad_u8 v45, v118, v53, v45
    v_pk_add_f32 v[96:97], v[96:97], v[116:117]
    v_pk_add_f32 v[98:99], v[98:99], v[118:119]
    s_waitcnt vmcnt(2)
    v_msad_u8 v45, v120, v53, v45
    v_msad_u8 v45, v122, v53, v45
    v_pk_add_f32 v[96:97], v[96:97], v[120:121]
    v_pk_add_f32 v[98:99], v[98:99], v[122:123]
    s_waitcnt vmcnt(1)
    v_msad_u8 v45, v124, v53, v45
    v_msad_u8 v45, v126, v53, v45
    v_pk_add_f32 v[96:97], v[96:97], v[124:125]
    v_pk_add_f32 v[98:99], v[98:99], v[126:127]
    s_waitcnt vmcnt(0)
    v_msad_u8 v45, v128, v53, v45
    v_msad_u8 v45, v130, v53, v45
    v_pk_add_f32 v[96:97], v[96:97], v[128:129]
    v_pk_add_f32 v[98:99], v[98:99], v[130:131]
    v_cmp_ne_u32 vcc, 0, v45
    s_cbranch_vccz L_pdone_18
    s_sub_u32 s77, s77, 1
    s_cbranch_scc0 L_poll_17
L_pdone_18:
    v_add_f32_dpp v96, v96, v96 row_ror:8 row_mask:0xf bank_mask:0xf
    v_add_f32_dpp v97, v97, v97 row_ror:8 row_mask:0xf bank_mask:0xf
    v_add_f32_dpp v98, v98, v98 row_ror:8 row_mask:0xf bank_mask:0xf
    v_add_f32_dpp v99, v99, v99 row_ror:8 row_mask:0xf bank_mask:0xf
    v_permlane32_swap_b32 v96, v97
    s_nop 0
    v_permlane32_swap_b32 v98, v99
    v_add_f32 v96, v96, v97
    v_add_f32 v98, v98, v99
    s_nop 1
    v_permlane16_swap_b32 v96, v98
    v_add_f32 v96, v96, v98
    v_cvt_pk_bf16_f32 v96, v96, v96
    v_lshlrev_b32 v96, 16, v96
    v_mul_f32 v96, v96, v41
    v_cvt_pk_bf16_f32 v96, v96, v96
    v_lshlrev_b32 v96, 16, v96
    v_add_f32 v96, v96, v44
    v_cvt_pk_bf16_f32 v96, v96, v96
L_pad25:
    s_cbranch_execz L_walkret
    s_mov_b32 exec_lo, 0xff00ff
    s_mov_b32 exec_hi, 0xff00ff
    global_store_short v51, v96, s[24:25]
    s_mov_b64 exec, -1
    s_cmp_lg_u32 s2, 64
    s_cbranch_scc1 L_fin
    v_mov_b32 v8, s56
    v_mov_b32 v9, 0
    s_mov_b64 exec, 1
    global_store_dword v9, v8, s[28:29] sc1
    s_branch L_fin
L_ffn:
    s_barrier
    s_mov_b32 s44, s16
    s_mov_b32 s45, s17
    s_mov_b32 s46, 5308416
    s_mov_b32 s47, 0x20000
    v_lshrrev_b32 v60, 3, v0
    v_mul_u32_u24 v60, 9216, v60
    v_and_b32 v63, 7, v0
    v_bfe_u32 v61, v0, 4, 1
    v_lshlrev_b32 v61, 1, v61
    v_xor_b32 v63, v63, v61
    v_lshl_add_u32 v60, v63, 4, v60
    v_xor_b32 v61, 64, v60
    s_and_b32 s79, s64, 1
    s_lshl_b32 s79, s79, 6
    v_xor_b32 v60, s79, v60
    v_xor_b32 v61, s79, v61
    s_mul_i32 s79, s64, 663552
    s_lshl_b32 s80, s53, 7
    s_add_u32 s79, s79, s80
    s_mul_i32 s81, s64, 9216
    s_add_u32 m0, s81, 16384
    s_nop 0
    buffer_load_dwordx4 v60, s[44:47], s79 offen nt lds
    s_add_u32 m0, m0, 1024
    s_add_u32 s79, s79, 73728
    buffer_load_dwordx4 v61, s[44:47], s79 offen nt lds
    s_add_u32 m0, m0, 1024
    s_add_u32 s79, s79, 73728
    buffer_load_dwordx4 v60, s[44:47], s79 offen nt lds
    s_add_u32 m0, m0, 1024
    s_add_u32 s79, s79, 73728
    buffer_load_dwordx4 v61, s[44:47], s79 offen nt lds
    s_add_u32 m0, m0, 1024
    s_add_u32 s79, s79, 73728
    buffer_load_dwordx4 v60, s[44:47], s79 offen nt lds
    s_add_u32 m0, m0, 1024
    s_add_u32 s79, s79, 73728
    buffer_load_dwordx4 v61, s[44:47], s79 offen nt lds
    s_add_u32 m0, m0, 1024
    s_add_u32 s79, s79, 73728
    buffer_load_dwordx4 v60, s[44:47], s79 offen nt lds
    s_add_u32 m0, m0, 1024
    s_add_u32 s79, s79, 73728
    buffer_load_dwordx4 v61, s[44:47], s79 offen nt lds
    s_add_u32 m0, m0, 1024
    s_add_u32 s79, s79, 73728
    buffer_load_dwordx4 v60, s[44:47], s79 offen nt lds
    v_lshlrev_b32 v60, 2, v0
    s_mul_i32 s79, s64, 13824
    v_lshl_add_u32 v116, v0, 3, s79
    s_mul_i32 s79, s64, 2304
    v_lshl_add_u32 v62, v0, 3, s79
    s_mul_i32 s79, s64, 1312
    v_add_u32 v63, s79, v60
    s_add_u32 s30, s28, 13312
    s_addc_u32 s31, s29, 0
    s_mov_b32 s77, 400000
    s_branch L_poll_19_c
L_poll_19:
L_pad26:
    s_cbranch_execz L_walkret
    v_mov_b32 v104, 0
    v_mov_b32 v105, s56
    global_load_dwordx2 v[96:97], v116, s[30:31] offset:-2304 sc1
    global_load_dwordx2 v[98:99], v116, s[30:31] offset:-1792 sc1
    global_load_dwordx2 v[100:101], v116, s[30:31] offset:-1280 sc1
    global_load_dwordx2 v[102:103], v116, s[30:31] offset:-768 sc1
    s_mov_b32 exec_hi, 0
    global_load_dwordx2 v[104:105], v116, s[30:31] offset:-256 sc1
    s_mov_b64 exec, -1
    v_mov_b32 v114, 0
    v_mov_b32 v115, s56
    global_load_dwordx2 v[106:107], v116, s[30:31] offset:0 sc1
    global_load_dwordx2 v[108:109], v116, s[30:31] offset:512 sc1
    global_load_dwordx2 v[110:111], v116, s[30:31] offset:1024 sc1
    global_load_dwordx2 v[112:113], v116, s[30:31] offset:1536 sc1
    s_mov_b32 exec_hi, 0
    global_load_dwordx2 v[114:115], v116, s[30:31] offset:2048 sc1
    s_mov_b64 exec, -1
L_poll_19_c:
    s_waitcnt vmcnt(0)
    v_xor_b32 v97, s56, v97
    v_xor_b32 v99, s56, v99
    v_xor_b32 v101, s56, v101
    v_xor_b32 v103, s56, v103
    v_xor_b32 v105, s56, v105
    v_xor_b32 v107, s56, v107
    v_xor_b32 v109, s56, v109
    v_xor_b32 v111, s56, v111
    v_xor_b32 v113, s56, v113
    v_xor_b32 v115, s56, v115
    v_or3_b32 v58, v97, v99, v101
    v_or3_b32 v58, v58, v103, v105
    v_or3_b32 v58, v58, v107, v109
    v_or3_b32 v58, v58, v111, v113
    v_or_b32 v58, v58, v115
    v_cmp_ne_u32 vcc, 0, v58
    s_cbranch_vccz L_pdone_20
    s_sub_u32 s77, s77, 1
    s_cbranch_scc1 L_pdone_20
    s_sleep 1
    s_branch L_poll_19
L_pdone_20:
    v_lshlrev_b32 v28, 16, v96
    v_and_b32 v29, s69, v96
    v_lshlrev_b32 v30, 16, v98
    v_and_b32 v31, s69, v98
    v_lshlrev_b32 v32, 16, v100
    v_and_b32 v33, s69, v100
    v_lshlrev_b32 v34, 16, v102
    v_and_b32 v35, s69, v102
    v_lshlrev_b32 v36, 16, v104
    v_and_b32 v37, s69, v104
    v_lshlrev_b32 v38, 16, v106
    v_and_b32 v39, s69, v106
    v_lshlrev_b32 v40, 16, v108
    v_and_b32 v41, s69, v108
    v_lshlrev_b32 v42, 16, v110
    v_and_b32 v43, s69, v110
    v_lshlrev_b32 v44, 16, v112
    v_and_b32 v45, s69, v112
    v_lshlrev_b32 v46, 16, v114
    v_and_b32 v47, s69, v114
    s_barrier
    v_lshrrev_b32 v57, 4, v0
    v_bfe_u32 v56, v0, 2, 2
    v_and_b32 v59, 3, v0
    v_lshlrev_b32 v59, 3, v59
    v_lshl_add_u32 v56, v57, 3, v56
    s_cmp_ge_u32 s64, 4
    s_cbranch_scc1 L_now1
    s_lshl_b32 s81, s64, 1
    v_bfe_u32 v54, v0, 1, 1
L_pad27:
    s_cbranch_execz L_walkret
    v_add_u32 v54, s81, v54
    v_bfe_u32 v55, v0, 3, 2
    v_lshlrev_b32 v55, 1, v55
    v_xor_b32 v54, v54, v55
    v_lshrrev_b32 v58, 4, v0
    v_bfe_u32 v55, v0, 2, 2
    v_lshl_add_u32 v58, v58, 3, v55
    v_lshlrev_b32 v58, 7, v58
    v_lshl_add_u32 v58, v54, 4, v58
    v_and_b32 v55, 1, v0
    v_lshl_add_u32 v58, v55, 3, v58
    v_add_u32 v58, 16384, v58
    v_add_u32 v55, 36864, v58
    ds_read_b64_tr_b16 v[180:181], v58 offset:0
    ds_read_b64_tr_b16 v[182:183], v58 offset:512
    ds_read_b64_tr_b16 v[184:185], v58 offset:4096
    ds_read_b64_tr_b16 v[186:187], v58 offset:4608
    ds_read_b64_tr_b16 v[188:189], v58 offset:8192
    ds_read_b64_tr_b16 v[190:191], v58 offset:8704
    ds_read_b64_tr_b16 v[192:193], v58 offset:12288
    ds_read_b64_tr_b16 v[194:195], v58 offset:12800
    ds_read_b64_tr_b16 v[196:197], v58 offset:16384
    ds_read_b64_tr_b16 v[198:199], v58 offset:16896
    ds_read_b64_tr_b16 v[200:201], v58 offset:20480
    ds_read_b64_tr_b16 v[202:203], v58 offset:20992
    ds_read_b64_tr_b16 v[204:205], v58 offset:24576
    ds_read_b64_tr_b16 v[206:207], v58 offset:25088
    ds_read_b64_tr_b16 v[208:209], v58 offset:28672
    ds_read_b64_tr_b16 v[210:211], v58 offset:29184
    ds_read_b64_tr_b16 v[212:213], v58 offset:32768
    ds_read_b64_tr_b16 v[214:215], v58 offset:33280
    ds_read_b64_tr_b16 v[216:217], v55 offset:0
    ds_read_b64_tr_b16 v[218:219], v55 offset:512
    ds_read_b64_tr_b16 v[220:221], v55 offset:4096
    ds_read_b64_tr_b16 v[222:223], v55 offset:4608
    ds_read_b64_tr_b16 v[224:225], v55 offset:8192
    ds_read_b64_tr_b16 v[226:227], v55 offset:8704
    ds_read_b64_tr_b16 v[228:229], v55 offset:12288
    ds_read_b64_tr_b16 v[230:231], v55 offset:12800
    ds_read_b64_tr_b16 v[232:233], v55 offset:16384
    ds_read_b64_tr_b16 v[234:235], v55 offset:16896
    ds_read_b64_tr_b16 v[236:237], v55 offset:20480
    ds_read_b64_tr_b16 v[238:239], v55 offset:20992
    ds_read_b64_tr_b16 v[240:241], v55 offset:24576
    ds_read_b64_tr_b16 v[242:243], v55 offset:25088
    ds_read_b64_tr_b16 v[244:245], v55 offset:28672
    ds_read_b64_tr_b16 v[246:247], v55 offset:29184
    ds_read_b64_tr_b16 v[248:249], v55 offset:32768
    ds_read_b64_tr_b16 v[250:251], v55 offset:33280
L_now1:
    v_mul_u32_u24 v58, 1152, v56
    v_add_u32 v58, v58, v59
    s_lshl_b32 s81, s64, 6
    s_add_u32 s81, s81, 90112
    v_add_u32 v58, s81, v58
    ds_read_b64_tr_b16 v[132:133], v58 offset:0
    ds_read_b64_tr_b16 v[134:135], v58 offset:4608
    ds_read_b64_tr_b16 v[136:137], v58 offset:36864
    ds_read_b64_tr_b16 v[138:139], v58 offset:41472
    ds_read_b64_tr_b16 v[140:141], v58 offset:32
    ds_read_b64_tr_b16 v[142:143], v58 offset:4640
    ds_read_b64_tr_b16 v[144:145], v58 offset:36896
    ds_read_b64_tr_b16 v[146:147], v58 offset:41504
    ds_read_b64_tr_b16 v[148:149], v58 offset:512
L_pad28:
    s_cbranch_execz L_walkret
    ds_read_b64_tr_b16 v[150:151], v58 offset:5120
    ds_read_b64_tr_b16 v[152:153], v58 offset:37376
    ds_read_b64_tr_b16 v[154:155], v58 offset:41984
    ds_read_b64_tr_b16 v[156:157], v58 offset:544
    ds_read_b64_tr_b16 v[158:159], v58 offset:5152
    ds_read_b64_tr_b16 v[160:161], v58 offset:37408
    ds_read_b64_tr_b16 v[162:163], v58 offset:42016
    s_cmp_ge_u32 s64, 2
    s_cbranch_scc1 L_nop2
    ds_read_b64_tr_b16 v[164:165], v58 offset:1024
    ds_read_b64_tr_b16 v[166:167], v58 offset:5632
    ds_read_b64_tr_b16 v[168:169], v58 offset:37888
    ds_read_b64_tr_b16 v[170:171], v58 offset:42496
    ds_read_b64_tr_b16 v[172:173], v58 offset:1056
    ds_read_b64_tr_b16 v[174:175], v58 offset:5664
    ds_read_b64_tr_b16 v[176:177], v58 offset:37920
    ds_read_b64_tr_b16 v[178:179], v58 offset:42528
L_nop2:
    v_add_f32 v38, 1.0, v38
    v_add_f32 v39, 1.0, v39
    v_add_f32 v40, 1.0, v40
    v_add_f32 v41, 1.0, v41
    v_add_f32 v42, 1.0, v42
    v_add_f32 v43, 1.0, v43
    v_add_f32 v44, 1.0, v44
    v_add_f32 v45, 1.0, v45
    v_add_f32 v46, 1.0, v46
    v_add_f32 v47, 1.0, v47
    v_cvt_pk_bf16_f32 v8, v38, v39
    v_lshlrev_b32 v38, 16, v8
    v_and_b32 v39, s69, v8
    v_cvt_pk_bf16_f32 v9, v40, v41
    v_lshlrev_b32 v40, 16, v9
    v_and_b32 v41, s69, v9
    v_cvt_pk_bf16_f32 v10, v42, v43
    v_lshlrev_b32 v42, 16, v10
    v_and_b32 v43, s69, v10
    v_cvt_pk_bf16_f32 v11, v44, v45
    v_lshlrev_b32 v44, 16, v11
    v_and_b32 v45, s69, v11
    v_cvt_pk_bf16_f32 v12, v46, v47
    v_lshlrev_b32 v46, 16, v12
    v_and_b32 v47, s69, v12
    s_add_u32 s30, s28, 1933312
    s_addc_u32 s31, s29, 0
    v_and_b32 v56, 7, v0
    v_mul_u32_u24 v48, 1312, v56
    v_lshl_add_u32 v48, v57, 4, v48
    v_lshlrev_b32 v50, 4, v56
    v_lshl_add_u32 v50, v57, 7, v50
    v_lshrrev_b32 v49, 1, v57
    v_lshlrev_b32 v49, 7, v49
    v_lshl_add_u32 v49, v56, 4, v49
    v_and_b32 v55, 1, v57
    v_lshl_add_u32 v49, v55, 3, v49
    s_lshl_b32 s81, s64, 8
    v_add_u32 v49, s81, v49
    v_mul_u32_u24 v51, 2304, v56
    v_lshl_add_u32 v51, v57, 4, v51
    v_bfe_u32 v56, v0, 3, 1
    v_lshl_add_u32 v51, v56, 6, v51
    s_mul_i32 s83, s53, 18432
    s_lshl_b32 s80, s64, 7
    s_add_u32 s83, s83, s80
    s_add_u32 s83, s83, 1966080
    s_mov_b32 s58, 0xff00ff00
    s_mov_b32 s59, 0xff00ff00
L_pad29:
    s_cbranch_execz L_walkret
    s_mov_b32 s77, 400000
L_poll_21:
    v_mov_b32 v16, 0
    v_mov_b32 v17, s56
    global_load_dwordx2 v[8:9], v62, s[30:31] offset:0 sc1
    global_load_dwordx2 v[10:11], v62, s[30:31] offset:512 sc1
    global_load_dwordx2 v[12:13], v62, s[30:31] offset:1024 sc1
    global_load_dwordx2 v[14:15], v62, s[30:31] offset:1536 sc1
    s_mov_b32 exec_hi, 0
    global_load_dwordx2 v[16:17], v62, s[30:31] offset:2048 sc1
    s_mov_b64 exec, -1
    s_waitcnt vmcnt(0)
    v_xor_b32 v9, s56, v9
    v_xor_b32 v11, s56, v11
    v_xor_b32 v13, s56, v13
    v_xor_b32 v15, s56, v15
    v_xor_b32 v17, s56, v17
    v_or3_b32 v58, v9, v11, v13
    v_or3_b32 v58, v58, v15, v17
    v_cmp_ne_u32 vcc, 0, v58
    s_cbranch_vccz L_pdone_22
    s_sub_u32 s77, s77, 1
    s_cbranch_scc1 L_pdone_22
    s_branch L_poll_21
L_pdone_22:
    v_readfirstlane_b32 s79, v8
    v_lshlrev_b32 v64, 16, v8
    v_and_b32 v65, s69, v8
    v_lshlrev_b32 v66, 16, v10
    v_and_b32 v67, s69, v10
    v_lshlrev_b32 v68, 16, v12
    v_and_b32 v69, s69, v12
    v_lshlrev_b32 v70, 16, v14
    v_and_b32 v71, s69, v14
    v_lshlrev_b32 v72, 16, v16
    v_and_b32 v73, s69, v16
    s_lshl_b32 s79, s79, 16
    v_mov_b32 v90, s79
    v_mov_b32 v84, 0
    v_mov_b32 v85, 0
    v_pk_add_f32 v[76:77], v[64:65], v[90:91] op_sel:[0,0] op_sel_hi:[1,0] neg_lo:[0,1] neg_hi:[0,1]
    v_pk_add_f32 v[78:79], v[66:67], v[90:91] op_sel:[0,0] op_sel_hi:[1,0] neg_lo:[0,1] neg_hi:[0,1]
    v_pk_add_f32 v[80:81], v[68:69], v[90:91] op_sel:[0,0] op_sel_hi:[1,0] neg_lo:[0,1] neg_hi:[0,1]
    v_pk_add_f32 v[82:83], v[70:71], v[90:91] op_sel:[0,0] op_sel_hi:[1,0] neg_lo:[0,1] neg_hi:[0,1]
    s_mov_b32 exec_hi, 0
    v_pk_add_f32 v[84:85], v[72:73], v[90:91] op_sel:[0,0] op_sel_hi:[1,0] neg_lo:[0,1] neg_hi:[0,1]
    s_mov_b64 exec, -1
    v_pk_add_f32 v[88:89], v[76:77], v[78:79]
    v_pk_mul_f32 v[76:77], v[76:77], v[76:77]
    v_pk_add_f32 v[88:89], v[88:89], v[80:81]
    v_pk_fma_f32 v[76:77], v[78:79], v[78:79], v[76:77]
    v_pk_add_f32 v[88:89], v[88:89], v[82:83]
    v_pk_fma_f32 v[76:77], v[80:81], v[80:81], v[76:77]
    v_pk_add_f32 v[88:89], v[88:89], v[84:85]
    v_pk_fma_f32 v[76:77], v[82:83], v[82:83], v[76:77]
    v_add_f32 v88, v88, v89
    v_pk_fma_f32 v[76:77], v[84:85], v[84:85], v[76:77]
    v_add_f32 v76, v76, v77
    v_add_f32_dpp v88, v88, v88 row_ror:8 row_mask:0xf bank_mask:0xf
    s_nop 0
    v_add_f32_dpp v76, v76, v76 row_ror:8 row_mask:0xf bank_mask:0xf
    v_add_f32_dpp v88, v88, v88 row_ror:4 row_mask:0xf bank_mask:0xf
    s_nop 0
    v_add_f32_dpp v76, v76, v76 row_ror:4 row_mask:0xf bank_mask:0xf
    v_add_f32_dpp v88, v88, v88 row_ror:2 row_mask:0xf bank_mask:0xf
    s_nop 0
    v_add_f32_dpp v76, v76, v76 row_ror:2 row_mask:0xf bank_mask:0xf
    v_add_f32_dpp v88, v88, v88 row_ror:1 row_mask:0xf bank_mask:0xf
    s_nop 0
    v_add_f32_dpp v76, v76, v76 row_ror:1 row_mask:0xf bank_mask:0xf
    s_nop 1
    v_permlane32_swap_b32 v88, v76
L_pad30:
    s_cbranch_execz L_walkret
    v_add_f32 v88, v88, v76
    v_mov_b32 v76, v88
    s_nop 1
    v_permlane16_swap_b32 v88, v76
    v_add_f32 v88, v88, v76
    v_mov_b32 v76, v88
    s_nop 1
    v_permlane32_swap_b32 v88, v76
    v_mul_f32 v88, 0x3ae38e39, v88
    v_mul_f32 v76, 0x3ae38e39, v76
    v_fma_f32 v76, -v88, v88, v76
    v_add_f32 v88, v88, v90
    v_max_f32 v76, 0, v76
    v_add_f32 v76, 0x3727c5ac, v76
    v_rsq_f32 v76, v76
    v_pk_add_f32 v[64:65], v[64:65], v[88:89] op_sel:[0,0] op_sel_hi:[1,0] neg_lo:[0,1] neg_hi:[0,1]
    v_pk_add_f32 v[66:67], v[66:67], v[88:89] op_sel:[0,0] op_sel_hi:[1,0] neg_lo:[0,1] neg_hi:[0,1]
    v_pk_add_f32 v[68:69], v[68:69], v[88:89] op_sel:[0,0] op_sel_hi:[1,0] neg_lo:[0,1] neg_hi:[0,1]
    v_pk_add_f32 v[70:71], v[70:71], v[88:89] op_sel:[0,0] op_sel_hi:[1,0] neg_lo:[0,1] neg_hi:[0,1]
    v_pk_add_f32 v[72:73], v[72:73], v[88:89] op_sel:[0,0] op_sel_hi:[1,0] neg_lo:[0,1] neg_hi:[0,1]
    v_pk_mul_f32 v[38:39], v[38:39], v[76:77] op_sel:[0,0] op_sel_hi:[1,0]
    v_pk_mul_f32 v[40:41], v[40:41], v[76:77] op_sel:[0,0] op_sel_hi:[1,0]
    v_pk_mul_f32 v[42:43], v[42:43], v[76:77] op_sel:[0,0] op_sel_hi:[1,0]
    v_pk_mul_f32 v[44:45], v[44:45], v[76:77] op_sel:[0,0] op_sel_hi:[1,0]
    v_pk_mul_f32 v[46:47], v[46:47], v[76:77] op_sel:[0,0] op_sel_hi:[1,0]
    v_pk_fma_f32 v[64:65], v[64:65], v[38:39], v[28:29]
    v_pk_fma_f32 v[66:67], v[66:67], v[40:41], v[30:31]
    v_pk_fma_f32 v[68:69], v[68:69], v[42:43], v[32:33]
    v_pk_fma_f32 v[70:71], v[70:71], v[44:45], v[34:35]
    v_pk_fma_f32 v[72:73], v[72:73], v[46:47], v[36:37]
    v_cvt_pk_bf16_f32 v77, v64, v65
    v_cvt_pk_bf16_f32 v78, v66, v67
    v_cvt_pk_bf16_f32 v79, v68, v69
    v_cvt_pk_bf16_f32 v80, v70, v71
    v_cvt_pk_bf16_f32 v81, v72, v73
    ds_write_b32 v63, v77 offset:0
    ds_write_b32 v63, v78 offset:256
    ds_write_b32 v63, v79 offset:512
    ds_write_b32 v63, v80 offset:768
    ds_write_b32 v63, v81 offset:1024
    s_waitcnt lgkmcnt(0)
    s_barrier
    s_cmp_ge_u32 s64, 4
    s_cbranch_scc1 L_nof1
    ds_read_b128 v[64:67], v48 offset:0
    ds_read_b128 v[68:71], v48 offset:64
    ds_read_b128 v[72:75], v48 offset:128
    ds_read_b128 v[76:79], v48 offset:192
    ds_read_b128 v[80:83], v48 offset:256
    ds_read_b128 v[84:87], v48 offset:320
    ds_read_b128 v[88:91], v48 offset:384
    ds_read_b128 v[92:95], v48 offset:448
    ds_read_b128 v[96:99], v48 offset:512
    ds_read_b128 v[100:103], v48 offset:576
    ds_read_b128 v[104:107], v48 offset:640
    ds_read_b128 v[108:111], v48 offset:704
    ds_read_b128 v[112:115], v48 offset:768
    ds_read_b128 v[116:119], v48 offset:832
    ds_read_b128 v[120:123], v48 offset:896
    s_waitcnt lgkmcnt(14)
    v_mfma_f32_16x16x32_bf16 v[20:23], v[180:183], v[64:67], 0
    ds_read_b128 v[8:11], v48 offset:960
    s_waitcnt lgkmcnt(14)
    v_mfma_f32_16x16x32_bf16 v[20:23], v[184:187], v[68:71], v[20:23]
    ds_read_b128 v[12:15], v48 offset:1024
    s_waitcnt lgkmcnt(14)
    v_mfma_f32_16x16x32_bf16 v[20:23], v[188:191], v[72:75], v[20:23]
L_pad31:
    s_cbranch_execz L_walkret
    ds_read_b128 v[16:19], v48 offset:1088
    s_waitcnt lgkmcnt(14)
    v_mfma_f32_16x16x32_bf16 v[20:23], v[192:195], v[76:79], v[20:23]
    s_waitcnt lgkmcnt(13)
    v_mfma_f32_16x16x32_bf16 v[20:23], v[196:199], v[80:83], v[20:23]
    s_waitcnt lgkmcnt(12)
    v_mfma_f32_16x16x32_bf16 v[20:23], v[200:203], v[84:87], v[20:23]
    s_waitcnt lgkmcnt(11)
    v_mfma_f32_16x16x32_bf16 v[20:23], v[204:207], v[88:91], v[20:23]
    s_waitcnt lgkmcnt(10)
    v_mfma_f32_16x16x32_bf16 v[20:23], v[208:211], v[92:95], v[20:23]
    s_waitcnt lgkmcnt(9)
    v_mfma_f32_16x16x32_bf16 v[20:23], v[212:215], v[96:99], v[20:23]
    s_waitcnt lgkmcnt(8)
    v_mfma_f32_16x16x32_bf16 v[20:23], v[216:219], v[100:103], v[20:23]
    s_waitcnt lgkmcnt(7)
    v_mfma_f32_16x16x32_bf16 v[20:23], v[220:223], v[104:107], v[20:23]
    s_waitcnt lgkmcnt(6)
    v_mfma_f32_16x16x32_bf16 v[20:23], v[224:227], v[108:111], v[20:23]
    s_waitcnt lgkmcnt(5)
    v_mfma_f32_16x16x32_bf16 v[20:23], v[228:231], v[112:115], v[20:23]
    s_waitcnt lgkmcnt(4)
    v_mfma_f32_16x16x32_bf16 v[20:23], v[232:235], v[116:119], v[20:23]
    s_waitcnt lgkmcnt(3)
    v_mfma_f32_16x16x32_bf16 v[20:23], v[236:239], v[120:123], v[20:23]
    s_waitcnt lgkmcnt(2)
    v_mfma_f32_16x16x32_bf16 v[20:23], v[240:243], v[8:11], v[20:23]
    s_waitcnt lgkmcnt(1)
    v_mfma_f32_16x16x32_bf16 v[20:23], v[244:247], v[12:15], v[20:23]
    s_waitcnt lgkmcnt(0)
    v_mfma_f32_16x16x32_bf16 v[20:23], v[248:251], v[16:19], v[20:23]
    s_mov_b32 exec_lo, 0xff00ff
    s_mov_b32 exec_hi, 0xff00ff
    s_nop 5
    v_cvt_pk_bf16_f32 v20, v20, v21
    v_cvt_pk_bf16_f32 v21, v22, v23
    v_pk_max_i16 v20, v20, 0
    v_pk_max_i16 v21, v21, 0
    ds_write_b64 v49, v[20:21] offset:10496
    s_mov_b64 exec, -1
    s_waitcnt lgkmcnt(0)
L_nof1:
    s_barrier
    ds_read_b128 v[40:43], v50 offset:10496
    ds_read_b128 v[44:47], v50 offset:11008
    s_waitcnt lgkmcnt(0)
    v_mfma_f32_16x16x32_bf16 v[64:67], v[132:135], v[40:43], 0
    v_mfma_f32_16x16x32_bf16 v[64:67], v[136:139], v[44:47], v[64:67]
    v_mfma_f32_16x16x32_bf16 v[68:71], v[140:143], v[40:43], 0
    v_mfma_f32_16x16x32_bf16 v[68:71], v[144:147], v[44:47], v[68:71]
    v_mfma_f32_16x16x32_bf16 v[72:75], v[148:151], v[40:43], 0
    v_mfma_f32_16x16x32_bf16 v[72:75], v[152:155], v[44:47], v[72:75]
    s_nop 5
    v_cndmask_b32 v64, v64, v68, s[58:59]
    v_cndmask_b32 v65, v65, v69, s[58:59]
    v_cndmask_b32 v66, v66, v70, s[58:59]
    v_cndmask_b32 v67, v67, v71, s[58:59]
    v_bfi_b32 v64, v52, v53, v64
    v_bfi_b32 v66, v52, v53, v66
    buffer_store_dwordx4 v[64:67], v51, s[60:63], s83 offen offset:0 sc1
    v_mfma_f32_16x16x32_bf16 v[76:79], v[156:159], v[40:43], 0
    v_mfma_f32_16x16x32_bf16 v[76:79], v[160:163], v[44:47], v[76:79]
    s_cmp_ge_u32 s64, 2
    s_cbranch_scc1 L_ffn2
    v_mfma_f32_16x16x32_bf16 v[80:83], v[164:167], v[40:43], 0
    v_mfma_f32_16x16x32_bf16 v[80:83], v[168:171], v[44:47], v[80:83]
    s_nop 3
    v_cndmask_b32 v72, v72, v76, s[58:59]
    v_cndmask_b32 v73, v73, v77, s[58:59]
    v_cndmask_b32 v74, v74, v78, s[58:59]
    v_cndmask_b32 v75, v75, v79, s[58:59]
    v_bfi_b32 v72, v52, v53, v72
    v_bfi_b32 v74, v52, v53, v74
    buffer_store_dwordx4 v[72:75], v51, s[60:63], s83 offen offset:1024 sc1
    v_mfma_f32_16x16x32_bf16 v[84:87], v[172:175], v[40:43], 0
    v_mfma_f32_16x16x32_bf16 v[84:87], v[176:179], v[44:47], v[84:87]
L_pad32:
    s_cbranch_execz L_walkret
    s_nop 7
    v_cndmask_b32 v80, v80, v84, s[58:59]
    v_cndmask_b32 v81, v81, v85, s[58:59]
    v_cndmask_b32 v82, v82, v86, s[58:59]
    v_cndmask_b32 v83, v83, v87, s[58:59]
    v_bfi_b32 v80, v52, v53, v80
    v_bfi_b32 v82, v52, v53, v82
    buffer_store_dwordx4 v[80:83], v51, s[60:63], s83 offen offset:2048 sc1
    s_branch L_ffn_end
L_ffn2:
    s_nop 5
    v_cndmask_b32 v72, v72, v76, s[58:59]
    v_cndmask_b32 v73, v73, v77, s[58:59]
    v_cndmask_b32 v74, v74, v78, s[58:59]
    v_cndmask_b32 v75, v75, v79, s[58:59]
    v_bfi_b32 v72, v52, v53, v72
    v_bfi_b32 v74, v52, v53, v74
    buffer_store_dwordx4 v[72:75], v51, s[60:63], s83 offen offset:1024 sc1
L_ffn_end:
L_fin:
L_end:
    s_endpgm
.section .rodata,"a"
.p2align 6
.amdhsa_kernel adaLN_cond__gqa_block_cached__dense_activation_relu__decode_kernel
  .amdhsa_next_free_vgpr 256
  .amdhsa_next_free_sgpr 102
  .amdhsa_accum_offset 256
  .amdhsa_float_denorm_mode_32 3
  .amdhsa_group_segment_fixed_size 0
  .amdhsa_kernarg_size 104
  .amdhsa_user_sgpr_count 2
  .amdhsa_user_sgpr_kernarg_segment_ptr 1
  .amdhsa_system_sgpr_workgroup_id_x 1
.end_amdhsa_kernel
```
